```python
import torch

def _softmax(x, axis=-1):
    return torch.softmax(x, dim=axis)
def _gelu(x):
    return torch.nn.functional.gelu(x, approximate="tanh")
def _silu(x):
    return torch.nn.functional.silu(x)
def _sigmoid(x):
    return torch.sigmoid(x)
def _layernorm(x, axis=-1, eps=1e-5):
    m = x.mean(dim=axis, keepdim=True)
    v = x.var(dim=axis, keepdim=True, unbiased=False)
    return (x - m) / torch.sqrt(v + eps)
def _scatter_add(tgt, idx, src, axis=0):
    return tgt.clone().index_add_(axis, idx, src)
def _segment_sum(src, seg, n):
    out = torch.zeros((n,) + src.shape[1:], dtype=src.dtype)
    return out.index_add_(0, seg, src)
def _pad(x, pw):
    flat = tuple(v for pair in reversed(pw) for v in pair)
    return torch.nn.functional.pad(x, flat)

kernel_name = 'recurrent_scan__ssm_conv_s4__glu_gated_glu__prompt'

def setup_inputs():

    _w = (lambda a: (lambda t: t.to(torch.bfloat16) if t.is_floating_point() else t)(torch.as_tensor(a)))
    def _A_setup():
        B, L, D, N = 1, 2048, 512, 128
        A_re = -(lambda _x: torch.exp(torch.as_tensor(_x)))((lambda *s: torch.randn(*s, dtype=torch.bfloat16) * 6.4)(D, N))
        A_im = torch.pi * (lambda *s: torch.randn(*s, dtype=torch.bfloat16) * 0.05)(D, N)
        B_re = (lambda *s: torch.randn(*s, dtype=torch.bfloat16) * 0.05)(D, N)
        B_im = (lambda *s: torch.randn(*s, dtype=torch.bfloat16) * 0.05)(D, N)
        C_re = (lambda *s: torch.randn(*s, dtype=torch.bfloat16) * 0.05)(D, N)
        C_im = (lambda *s: torch.randn(*s, dtype=torch.bfloat16) * 0.05)(D, N)
        log_dt = (lambda *s: torch.randn(*s, dtype=torch.bfloat16) * 0.05)(D) * 0.5 - 4.0
        Dskip = (lambda *s: torch.randn(*s, dtype=torch.bfloat16) * 0.05)(D)
        return {
            "u": _w((lambda *s: torch.randn(*s, dtype=torch.bfloat16) * 0.05)(B, L, D)),
            "A_re": _w(A_re),
            "A_im": _w(A_im),
            "B_re": _w(B_re),
            "B_im": _w(B_im),
            "C_re": _w(C_re),
            "C_im": _w(C_im),
            "log_dt": _w(log_dt),
            "Dskip": _w(Dskip),
        }
    _A_in = _A_setup()

    def _B_setup():
        B, S, D, F = 1, 2048, 512, 1792
        return {
            "x": _w((lambda *s: torch.randn(*s, dtype=torch.bfloat16) * 0.05)(B, S, D)),
            "w_gate": _w((lambda *s: torch.randn(*s, dtype=torch.bfloat16) * 0.05)(D, F)),
            "w_up": _w((lambda *s: torch.randn(*s, dtype=torch.bfloat16) * 0.05)(D, F)),
            "w_down": _w((lambda *s: torch.randn(*s, dtype=torch.bfloat16) * 0.05)(F, D)),
        }
    _B_in = _B_setup()

    return {
        "A_u": _A_in["u"],
        "A_A_re": _A_in["A_re"],
        "A_A_im": _A_in["A_im"],
        "A_B_re": _A_in["B_re"],
        "A_B_im": _A_in["B_im"],
        "A_C_re": _A_in["C_re"],
        "A_C_im": _A_in["C_im"],
        "A_log_dt": _A_in["log_dt"],
        "A_Dskip": _A_in["Dskip"],
        "B_x": _B_in["x"],
        "B_w_gate": _B_in["w_gate"],
        "B_w_up": _B_in["w_up"],
        "B_w_down": _B_in["w_down"],
    }

def reference(A_u, A_A_re, A_A_im, A_B_re, A_B_im, A_C_re, A_C_im, A_log_dt, A_Dskip, B_x, B_w_gate, B_w_up, B_w_down):
    def _A_ref(u, A_re, A_im, B_re, B_im, C_re, C_im, log_dt, Dskip):
        Bsz, L, D = u.shape
        dt = torch.exp(log_dt)[:, None]
        A = A_re + 1j * A_im
        Bc = B_re + 1j * B_im
        Cc = C_re + 1j * C_im
        logdA = dt * A
        dB = dt * Bc
        l = (lambda x, dt: x.to(dt))(torch.arange(L), A_re.dtype)
        P = torch.exp(logdA[:, :, None] * l[None, None, :])
        K = torch.einsum("dn,dnl,dn->dl", Cc, P, dB).real
        L2 = 2 * L
        Kp = _pad(K, ((0, 0), (0, L)))
        up = (lambda x, *d: x.permute(*d))(u, 0, 2, 1)
        up = _pad(up, ((0, 0), (0, 0), (0, L)))
        Kf = (lambda x, axes=(-2,-1): torch.fft.rfft2(x.float(), dim=axes))(Kp[:, None, :], axes=(-2, -1))
        Uf = (lambda x, axes=(-2,-1): torch.fft.rfft2(x.float(), dim=axes))(up[:, :, None, :], axes=(-2, -1))
        Yf = Uf * Kf[None, :, :, :]
        y = (lambda x, s, axes=(-2,-1): torch.fft.irfft2(x, s=s, dim=axes).to(torch.bfloat16))(Yf, (1, L2), axes=(-2, -1))[:, :, 0, :L]
        y = (lambda x, *d: x.permute(*d))(y, 0, 2, 1) + u * Dskip[None, None, :]
        return y

    def _B_ref(x, w_gate, w_up, w_down):
        g = torch.einsum("bsd,df->bsf", x, w_gate)
        u = torch.einsum("bsd,df->bsf", x, w_up)
        h = _sigmoid(g) * u
        return torch.einsum("bsf,fd->bsd", h, w_down)

    x = A_u
    xn = _layernorm(x, axis=-1)
    s = _A_ref(xn, A_A_re, A_A_im, A_B_re, A_B_im, A_C_re, A_C_im, A_log_dt, A_Dskip)
    g = _silu(_B_ref(xn, B_w_gate, B_w_up, B_w_down))
    return x + s * g
```

```asm
; @launch grid=(512,1,1) block=(256,1,1) lds=81920
.amdgcn_target "amdgcn-amd-amdhsa--gfx950"
.text
.globl recurrent_scan__ssm_conv_s4__glu_gated_glu__prompt_kernel
.p2align 8
.type recurrent_scan__ssm_conv_s4__glu_gated_glu__prompt_kernel,@function
recurrent_scan__ssm_conv_s4__glu_gated_glu__prompt_kernel:
  s_cmp_ge_u32 s2, 512
  s_cbranch_scc1 Lend
  s_load_dwordx16 s[16:31], s[0:1], 0
  s_load_dwordx16 s[32:47], s[0:1], 64
  v_lshrrev_b32 v1, 6, v0
  v_and_b32 v0, 63, v0
  v_readfirstlane_b32 s50, v1
  s_and_b32 s3, s2, 255
  s_and_b32 s4, s3, 7
  s_lshr_b32 s5, s3, 3
  s_lshr_b32 s6, s4, 1
  s_lshl_b32 s6, s6, 2
  s_and_b32 s7, s5, 3
  s_add_u32 s48, s6, s7
  s_and_b32 s6, s4, 1
  s_lshl_b32 s6, s6, 3
  s_lshr_b32 s7, s5, 2
  s_add_u32 s49, s6, s7
  s_waitcnt lgkmcnt(0)
  s_cmp_ge_u32 s2, 256
  s_cbranch_scc1 LprogX
  s_lshl_b32 s51, s48, 7
  s_lshl_b32 s52, s49, 3
  s_add_u32 s91, s51, s52
  s_lshl_b32 s51, s50, 1
  s_add_u32 s51, s51, s91
  s_lshl_b32 s52, s51, 10
  s_add_u32 s92, s16, s52
  s_addc_u32 s93, s17, 0
  v_lshlrev_b32 v3, 4, v0
  global_load_dwordx4 v[4:7], v3, s[92:93]
  global_load_dwordx4 v[44:47], v3, s[92:93] offset:1024
  s_or_b32 s6, s2, s50
  s_cmp_lg_u32 s6, 0
  s_cbranch_scc1 Lnp_1
  s_memrealtime s[6:7]
  s_waitcnt lgkmcnt(0)
  s_or_b32 s6, s6, 1
  v_mov_b32 v244, 0
  v_mov_b32 v246, s6
  v_mov_b32 v247, s7
  s_mov_b64 s[6:7], exec
  s_mov_b64 exec, 1
  global_store_dwordx2 v244, v[246:247], s[44:45] sc1
  s_mov_b64 exec, s[6:7]
Lnp_1:
  s_mov_b32 s52, s36
  s_and_b32 s53, s37, 0xffff
  s_mov_b32 s54, 1835008
  s_mov_b32 s55, 0x00020000
  s_mov_b32 s56, s38
  s_and_b32 s57, s39, 0xffff
  s_mov_b32 s58, 1835008
  s_mov_b32 s59, 0x00020000
  v_lshrrev_b32 v242, 3, v0
  v_bfe_u32 v243, v0, 1, 2
  v_and_b32 v238, 1, v0
  v_bfe_u32 v239, v242, 1, 1
  v_xor_b32 v239, v243, v239
  v_xor_b32 v243, 2, v239
  v_mul_u32_u24 v242, 3584, v242
  v_lshl_add_u32 v242, v238, 4, v242
  v_lshl_add_u32 v240, v239, 5, v242
  v_lshl_add_u32 v241, v243, 5, v242
  s_mul_i32 s60, s49, 224
  s_mul_i32 s61, s50, 28672
  s_add_u32 s60, s60, s61
  s_lshl_b32 s62, s50, 10
  s_waitcnt vmcnt(0)
  v_lshlrev_b32 v8, 16, v4
  v_lshlrev_b32 v48, 16, v44
  v_and_b32 v9, 0xffff0000, v4
  v_and_b32 v49, 0xffff0000, v44
  v_lshlrev_b32 v10, 16, v5
  v_lshlrev_b32 v50, 16, v45
  v_and_b32 v11, 0xffff0000, v5
  v_and_b32 v51, 0xffff0000, v45
  v_lshlrev_b32 v12, 16, v6
  v_lshlrev_b32 v52, 16, v46
  v_and_b32 v13, 0xffff0000, v6
  v_and_b32 v53, 0xffff0000, v46
  v_lshlrev_b32 v14, 16, v7
  v_lshlrev_b32 v54, 16, v47
  v_and_b32 v15, 0xffff0000, v7
  v_and_b32 v55, 0xffff0000, v47
  v_add_f32 v16, v8, v9
  v_add_f32 v56, v48, v49
  v_add_f32 v17, v10, v11
  v_add_f32 v57, v50, v51
  v_add_f32 v18, v12, v13
  v_add_f32 v58, v52, v53
  v_add_f32 v19, v14, v15
  v_add_f32 v59, v54, v55
  v_add_f32 v16, v16, v17
  v_add_f32 v56, v56, v57
  v_add_f32 v18, v18, v19
  v_add_f32 v58, v58, v59
  v_add_f32 v16, v16, v18
  v_add_f32 v56, v56, v58
  s_nop 0
  s_nop 0
  v_add_f32_dpp v16, v16, v16 row_shr:1 row_mask:0xf bank_mask:0xf bound_ctrl:0
  v_add_f32_dpp v56, v56, v56 row_shr:1 row_mask:0xf bank_mask:0xf bound_ctrl:0
  s_nop 0
  s_nop 0
  v_add_f32_dpp v16, v16, v16 row_shr:2 row_mask:0xf bank_mask:0xf bound_ctrl:0
  v_add_f32_dpp v56, v56, v56 row_shr:2 row_mask:0xf bank_mask:0xf bound_ctrl:0
  s_nop 0
  s_nop 0
  v_add_f32_dpp v16, v16, v16 row_shr:4 row_mask:0xf bank_mask:0xf bound_ctrl:0
  v_add_f32_dpp v56, v56, v56 row_shr:4 row_mask:0xf bank_mask:0xf bound_ctrl:0
  s_nop 0
  s_nop 0
  v_add_f32_dpp v16, v16, v16 row_shr:8 row_mask:0xf bank_mask:0xf bound_ctrl:0
  v_add_f32_dpp v56, v56, v56 row_shr:8 row_mask:0xf bank_mask:0xf bound_ctrl:0
  s_nop 0
  s_nop 0
  v_add_f32_dpp v16, v16, v16 row_bcast:15 row_mask:0xa bank_mask:0xf
  v_add_f32_dpp v56, v56, v56 row_bcast:15 row_mask:0xa bank_mask:0xf
  s_nop 0
  s_nop 0
  v_add_f32_dpp v16, v16, v16 row_bcast:31 row_mask:0xc bank_mask:0xf
  v_add_f32_dpp v56, v56, v56 row_bcast:31 row_mask:0xc bank_mask:0xf
  s_nop 0
  s_nop 0
  v_readlane_b32 s94, v16, 63
  v_readlane_b32 s96, v56, 63
  s_nop 1
  s_nop 1
  v_mov_b32 v17, s94
  v_mov_b32 v57, s96
  v_mul_f32 v17, 0x3b000000, v17
  v_mul_f32 v57, 0x3b000000, v57
  v_sub_f32 v20, v8, v17
  v_sub_f32 v60, v48, v57
  v_sub_f32 v21, v9, v17
  v_sub_f32 v61, v49, v57
  v_sub_f32 v22, v10, v17
  v_sub_f32 v62, v50, v57
  v_sub_f32 v23, v11, v17
  v_sub_f32 v63, v51, v57
  v_sub_f32 v24, v12, v17
  v_sub_f32 v64, v52, v57
  v_sub_f32 v25, v13, v17
  v_sub_f32 v65, v53, v57
  v_sub_f32 v26, v14, v17
  v_sub_f32 v66, v54, v57
  v_sub_f32 v27, v15, v17
  v_sub_f32 v67, v55, v57
  v_mul_f32 v16, v20, v20
  v_mul_f32 v56, v60, v60
  v_fmac_f32 v16, v21, v21
  v_fmac_f32 v56, v61, v61
  v_fmac_f32 v16, v22, v22
  v_fmac_f32 v56, v62, v62
  v_fmac_f32 v16, v23, v23
  v_fmac_f32 v56, v63, v63
  v_fmac_f32 v16, v24, v24
  v_fmac_f32 v56, v64, v64
  v_fmac_f32 v16, v25, v25
  v_fmac_f32 v56, v65, v65
  v_fmac_f32 v16, v26, v26
  v_fmac_f32 v56, v66, v66
  v_fmac_f32 v16, v27, v27
  v_fmac_f32 v56, v67, v67
  s_nop 0
  s_nop 0
  v_add_f32_dpp v16, v16, v16 row_shr:1 row_mask:0xf bank_mask:0xf bound_ctrl:0
  v_add_f32_dpp v56, v56, v56 row_shr:1 row_mask:0xf bank_mask:0xf bound_ctrl:0
  s_nop 0
  s_nop 0
  v_add_f32_dpp v16, v16, v16 row_shr:2 row_mask:0xf bank_mask:0xf bound_ctrl:0
  v_add_f32_dpp v56, v56, v56 row_shr:2 row_mask:0xf bank_mask:0xf bound_ctrl:0
  s_nop 0
  s_nop 0
  v_add_f32_dpp v16, v16, v16 row_shr:4 row_mask:0xf bank_mask:0xf bound_ctrl:0
  v_add_f32_dpp v56, v56, v56 row_shr:4 row_mask:0xf bank_mask:0xf bound_ctrl:0
  s_nop 0
  s_nop 0
  v_add_f32_dpp v16, v16, v16 row_shr:8 row_mask:0xf bank_mask:0xf bound_ctrl:0
  v_add_f32_dpp v56, v56, v56 row_shr:8 row_mask:0xf bank_mask:0xf bound_ctrl:0
  s_nop 0
  s_nop 0
  v_add_f32_dpp v16, v16, v16 row_bcast:15 row_mask:0xa bank_mask:0xf
  v_add_f32_dpp v56, v56, v56 row_bcast:15 row_mask:0xa bank_mask:0xf
  s_nop 0
  s_nop 0
  v_add_f32_dpp v16, v16, v16 row_bcast:31 row_mask:0xc bank_mask:0xf
  v_add_f32_dpp v56, v56, v56 row_bcast:31 row_mask:0xc bank_mask:0xf
  s_nop 0
  s_nop 0
  v_readlane_b32 s95, v16, 63
  v_readlane_b32 s97, v56, 63
  s_nop 1
  s_nop 1
  v_mov_b32 v18, s95
  v_mov_b32 v58, s97
  v_mul_f32 v18, 0x3b000000, v18
  v_mul_f32 v58, 0x3b000000, v58
  v_cvt_pk_bf16_f32 v18, v18, v18
  v_cvt_pk_bf16_f32 v58, v58, v58
  v_lshlrev_b32 v18, 16, v18
  v_lshlrev_b32 v58, 16, v58
  v_add_f32 v18, 0x3727c5ac, v18
  v_add_f32 v58, 0x3727c5ac, v58
  v_cvt_pk_bf16_f32 v18, v18, v18
  v_cvt_pk_bf16_f32 v58, v58, v58
  v_lshlrev_b32 v18, 16, v18
  v_lshlrev_b32 v58, 16, v58
  v_sqrt_f32 v18, v18
  v_sqrt_f32 v58, v58
  s_nop 0
  s_nop 0
  v_cvt_pk_bf16_f32 v18, v18, v18
  v_cvt_pk_bf16_f32 v58, v58, v58
  v_lshlrev_b32 v18, 16, v18
  v_lshlrev_b32 v58, 16, v58
  v_rcp_f32 v19, v18
  v_rcp_f32 v59, v58
  v_cvt_pk_bf16_f32 v17, v17, v17
  v_cvt_pk_bf16_f32 v57, v57, v57
  v_lshlrev_b32 v17, 16, v17
  v_lshlrev_b32 v57, 16, v57
  v_sub_f32 v20, v8, v17
  v_sub_f32 v60, v48, v57
  v_sub_f32 v21, v9, v17
  v_sub_f32 v61, v49, v57
  v_sub_f32 v22, v10, v17
  v_sub_f32 v62, v50, v57
  v_sub_f32 v23, v11, v17
  v_sub_f32 v63, v51, v57
  v_sub_f32 v24, v12, v17
  v_sub_f32 v64, v52, v57
  v_sub_f32 v25, v13, v17
  v_sub_f32 v65, v53, v57
  v_sub_f32 v26, v14, v17
  v_sub_f32 v66, v54, v57
  v_sub_f32 v27, v15, v17
  v_sub_f32 v67, v55, v57
  v_cvt_pk_bf16_f32 v28, v20, v21
  v_cvt_pk_bf16_f32 v68, v60, v61
  v_cvt_pk_bf16_f32 v29, v22, v23
  v_cvt_pk_bf16_f32 v69, v62, v63
  v_cvt_pk_bf16_f32 v30, v24, v25
  v_cvt_pk_bf16_f32 v70, v64, v65
  v_cvt_pk_bf16_f32 v31, v26, v27
  v_cvt_pk_bf16_f32 v71, v66, v67
  v_lshlrev_b32 v20, 16, v28
  v_lshlrev_b32 v60, 16, v68
  v_and_b32 v21, 0xffff0000, v28
  v_and_b32 v61, 0xffff0000, v68
  v_lshlrev_b32 v22, 16, v29
  v_lshlrev_b32 v62, 16, v69
  v_and_b32 v23, 0xffff0000, v29
  v_and_b32 v63, 0xffff0000, v69
  v_lshlrev_b32 v24, 16, v30
  v_lshlrev_b32 v64, 16, v70
  v_and_b32 v25, 0xffff0000, v30
  v_and_b32 v65, 0xffff0000, v70
  v_lshlrev_b32 v26, 16, v31
  v_lshlrev_b32 v66, 16, v71
  v_and_b32 v27, 0xffff0000, v31
  v_and_b32 v67, 0xffff0000, v71
  v_mul_f32 v8, v20, v19
  v_mul_f32 v48, v60, v59
  v_fma_f32 v32, -v8, v18, v20
  v_fma_f32 v72, -v48, v58, v60
  v_fma_f32 v8, v32, v19, v8
  v_fma_f32 v48, v72, v59, v48
  v_mul_f32 v9, v21, v19
  v_mul_f32 v49, v61, v59
  v_fma_f32 v33, -v9, v18, v21
  v_fma_f32 v73, -v49, v58, v61
  v_fma_f32 v9, v33, v19, v9
  v_fma_f32 v49, v73, v59, v49
  v_mul_f32 v10, v22, v19
  v_mul_f32 v50, v62, v59
  v_fma_f32 v34, -v10, v18, v22
  v_fma_f32 v74, -v50, v58, v62
  v_fma_f32 v10, v34, v19, v10
  v_fma_f32 v50, v74, v59, v50
  v_mul_f32 v11, v23, v19
  v_mul_f32 v51, v63, v59
  v_fma_f32 v35, -v11, v18, v23
  v_fma_f32 v75, -v51, v58, v63
  v_fma_f32 v11, v35, v19, v11
  v_fma_f32 v51, v75, v59, v51
  v_mul_f32 v12, v24, v19
  v_mul_f32 v52, v64, v59
  v_fma_f32 v36, -v12, v18, v24
  v_fma_f32 v76, -v52, v58, v64
  v_fma_f32 v12, v36, v19, v12
  v_fma_f32 v52, v76, v59, v52
  v_mul_f32 v13, v25, v19
  v_mul_f32 v53, v65, v59
  v_fma_f32 v37, -v13, v18, v25
  v_fma_f32 v77, -v53, v58, v65
  v_fma_f32 v13, v37, v19, v13
  v_fma_f32 v53, v77, v59, v53
  v_mul_f32 v14, v26, v19
  v_mul_f32 v54, v66, v59
  v_fma_f32 v38, -v14, v18, v26
  v_fma_f32 v78, -v54, v58, v66
  v_fma_f32 v14, v38, v19, v14
  v_fma_f32 v54, v78, v59, v54
  v_mul_f32 v15, v27, v19
  v_mul_f32 v55, v67, v59
  v_fma_f32 v39, -v15, v18, v27
  v_fma_f32 v79, -v55, v58, v67
  v_fma_f32 v15, v39, v19, v15
  v_fma_f32 v55, v79, v59, v55
  v_cvt_pk_bf16_f32 v4, v8, v9
  v_cvt_pk_bf16_f32 v44, v48, v49
  v_cvt_pk_bf16_f32 v5, v10, v11
  v_cvt_pk_bf16_f32 v45, v50, v51
  v_cvt_pk_bf16_f32 v6, v12, v13
  v_cvt_pk_bf16_f32 v46, v52, v53
  v_cvt_pk_bf16_f32 v7, v14, v15
  v_cvt_pk_bf16_f32 v47, v54, v55
  s_mul_i32 s94, s50, 2080
  s_add_u32 s94, s94, 65536
  v_lshlrev_b32 v3, 4, v0
  v_add_u32 v3, s94, v3
  ds_write_b128 v3, v[4:7]
  ds_write_b128 v3, v[44:47] offset:1040
  v_and_b32 v8, 7, v0
  v_lshrrev_b32 v9, 3, v0
  s_lshl_b32 s94, s50, 4
  v_add_u32 v9, s94, v9
  v_mul_u32_u24 v10, 1040, v8
  v_lshl_add_u32 v10, v9, 4, v10
  v_add_u32 v10, 65536, v10
  s_waitcnt lgkmcnt(0)
  s_barrier
  ds_read_b128 v[4:7], v10
  ds_read_b128 v[12:15], v10 offset:128
  v_lshlrev_b32 v11, 11, v9
  s_lshl_b32 s94, s49, 3
  v_add_u32 v16, s94, v8
  v_lshl_add_u32 v11, v16, 4, v11
  s_lshl_b32 s94, s48, 17
  s_add_u32 s92, s46, s94
  s_addc_u32 s93, s47, 0
  v_add_u32 v17, 16384, v11
  s_waitcnt lgkmcnt(0)
  global_store_dwordx4 v11, v[4:7], s[92:93] sc1
  global_store_dwordx4 v17, v[12:15], s[92:93] sc1
  s_cmp_lg_u32 s50, 0
  s_cbranch_scc1 Lng_2
  v_mov_b32 v244, 0
  s_mov_b32 s6, 0
Lngp_3:
  global_load_dwordx2 v[246:247], v244, s[44:45] sc1
  s_waitcnt vmcnt(0)
  v_cmp_eq_u32 vcc, 0, v246
  s_add_u32 s6, s6, 1
  s_cmp_gt_u32 s6, 200000
  s_cbranch_scc1 Lngd_4
  s_cbranch_vccz Lngd_4
  s_sleep 2
  s_branch Lngp_3
Lngd_4:
  v_readfirstlane_b32 s8, v246
  v_readfirstlane_b32 s9, v247
Lng_2:
  s_waitcnt vmcnt(0)
  s_barrier
  s_cmp_lg_u32 s50, 0
  s_cbranch_scc1 Lfs_5
  s_lshl_b32 s6, s48, 4
  s_add_u32 s6, s6, s49
  s_lshl_b32 s6, s6, 3
  s_add_u32 s6, s6, 12582912
  v_mov_b32 v244, s6
  v_mov_b32 v246, s8
  v_mov_b32 v247, s9
  s_mov_b64 s[6:7], exec
  s_mov_b64 exec, 1
  global_store_dwordx2 v244, v[246:247], s[46:47] sc1
  s_mov_b64 exec, s[6:7]
Lfs_5:
  s_add_u32 s61, s60, 0
  s_add_u32 m0, s62, 0
  s_nop 0
  buffer_load_dwordx4 v240, s[52:55], s61 offen lds
  s_add_u32 m0, s62, 4096
  s_nop 0
  buffer_load_dwordx4 v241, s[56:59], s61 offen lds
  s_add_u32 s61, s60, 114688
  s_add_u32 m0, s62, 8192
  s_nop 0
  buffer_load_dwordx4 v240, s[52:55], s61 offen lds
  s_add_u32 m0, s62, 12288
  s_nop 0
  buffer_load_dwordx4 v241, s[56:59], s61 offen lds
  s_add_u32 s61, s60, 229376
  s_add_u32 m0, s62, 16384
  s_nop 0
  buffer_load_dwordx4 v240, s[52:55], s61 offen lds
  s_add_u32 m0, s62, 20480
  s_nop 0
  buffer_load_dwordx4 v241, s[56:59], s61 offen lds
  s_add_u32 s61, s60, 344064
  s_add_u32 m0, s62, 24576
  s_nop 0
  buffer_load_dwordx4 v240, s[52:55], s61 offen lds
  s_add_u32 m0, s62, 28672
  s_nop 0
  buffer_load_dwordx4 v241, s[56:59], s61 offen lds
  s_add_u32 s61, s60, 458752
  s_add_u32 m0, s62, 32768
  s_nop 0
  buffer_load_dwordx4 v240, s[52:55], s61 offen lds
  s_add_u32 m0, s62, 36864
  s_nop 0
  buffer_load_dwordx4 v241, s[56:59], s61 offen lds
  s_add_u32 s61, s60, 573440
  s_add_u32 m0, s62, 40960
  s_nop 0
  buffer_load_dwordx4 v240, s[52:55], s61 offen lds
  s_add_u32 m0, s62, 45056
  s_nop 0
  buffer_load_dwordx4 v241, s[56:59], s61 offen lds
  s_add_u32 s61, s60, 688128
  s_add_u32 m0, s62, 49152
  s_nop 0
  buffer_load_dwordx4 v240, s[52:55], s61 offen lds
  s_add_u32 m0, s62, 53248
  s_nop 0
  buffer_load_dwordx4 v241, s[56:59], s61 offen lds
  s_add_u32 s61, s60, 802816
  s_add_u32 m0, s62, 57344
  s_nop 0
  buffer_load_dwordx4 v240, s[52:55], s61 offen lds
  s_add_u32 m0, s62, 61440
  s_nop 0
  buffer_load_dwordx4 v241, s[56:59], s61 offen lds
  s_cmp_lg_u32 s50, 0
  s_cbranch_scc1 Lpl_6
  v_and_b32 v244, 15, v0
  v_lshlrev_b32 v244, 3, v244
  s_mul_i32 s6, s48, 128
  s_add_u32 s6, s6, 12582912
  v_add_u32 v244, s6, v244
  s_mov_b32 s6, 0
Lplp_7:
  global_load_dwordx2 v[246:247], v244, s[46:47] offset:0 sc1
  s_waitcnt vmcnt(0)
  v_xor_b32 v246, s8, v246
  v_xor_b32 v247, s9, v247
  v_or_b32 v246, v246, v247
  v_cmp_ne_u32 vcc, 0, v246
  s_add_u32 s6, s6, 1
  s_cmp_gt_u32 s6, 200000
  s_cbranch_scc1 Lpld_8
  s_cbranch_vccz Lpld_8
  s_sleep 4
  s_branch Lplp_7
Lpld_8:
Lpl_6:
  s_barrier
  s_setprio 3
  s_lshl_b32 s63, s50, 5
  s_lshl_b32 s64, s48, 7
  s_add_u32 s63, s63, s64
  s_lshl_b32 s64, s50, 5
  v_and_b32 v1, 31, v0
  v_add_u32 v1, s64, v1
  v_lshrrev_b32 v2, 5, v0
  v_lshlrev_b32 v2, 11, v2
  v_lshl_add_u32 v1, v1, 4, v2
  s_lshl_b32 s65, s48, 17
  s_add_u32 s64, s46, s65
  s_addc_u32 s65, s47, 0
  global_load_dwordx4 v[8:11], v1, s[64:65] sc1
  s_add_u32 s64, s64, 4096
  s_addc_u32 s65, s65, 0
  global_load_dwordx4 v[12:15], v1, s[64:65] sc1
  s_add_u32 s64, s64, 4096
  s_addc_u32 s65, s65, 0
  global_load_dwordx4 v[16:19], v1, s[64:65] sc1
  s_add_u32 s64, s64, 4096
  s_addc_u32 s65, s65, 0
  global_load_dwordx4 v[20:23], v1, s[64:65] sc1
  s_add_u32 s64, s64, 4096
  s_addc_u32 s65, s65, 0
  global_load_dwordx4 v[24:27], v1, s[64:65] sc1
  s_add_u32 s64, s64, 4096
  s_addc_u32 s65, s65, 0
  global_load_dwordx4 v[28:31], v1, s[64:65] sc1
  s_add_u32 s64, s64, 4096
  s_addc_u32 s65, s65, 0
  global_load_dwordx4 v[32:35], v1, s[64:65] sc1
  s_add_u32 s64, s64, 4096
  s_addc_u32 s65, s65, 0
  global_load_dwordx4 v[36:39], v1, s[64:65] sc1
  s_add_u32 s64, s64, 4096
  s_addc_u32 s65, s65, 0
  global_load_dwordx4 v[40:43], v1, s[64:65] sc1
  s_add_u32 s64, s64, 4096
  s_addc_u32 s65, s65, 0
  global_load_dwordx4 v[44:47], v1, s[64:65] sc1
  s_add_u32 s64, s64, 4096
  s_addc_u32 s65, s65, 0
  global_load_dwordx4 v[48:51], v1, s[64:65] sc1
  s_add_u32 s64, s64, 4096
  s_addc_u32 s65, s65, 0
  global_load_dwordx4 v[52:55], v1, s[64:65] sc1
  s_add_u32 s64, s64, 4096
  s_addc_u32 s65, s65, 0
  v_lshrrev_b32 v2, 4, v0
  v_and_b32 v3, 1, v2
  v_lshrrev_b32 v2, 1, v2
  v_bfe_u32 v4, v0, 2, 2
  v_and_b32 v5, 3, v0
  v_lshrrev_b32 v6, 1, v4
  v_lshl_add_u32 v6, v3, 1, v6
  v_lshlrev_b32 v6, 5, v6
  v_lshl_add_u32 v7, v2, 3, v4
  v_lshlrev_b32 v7, 7, v7
  v_lshl_add_u32 v7, v3, 12, v7
  v_lshl_add_u32 v7, v5, 3, v7
  v_xor_b32 v232, 0, v6
  v_add_u32 v232, v232, v7
  v_xor_b32 v233, 32, v6
  v_add_u32 v233, v233, v7
  v_xor_b32 v234, 64, v6
  v_add_u32 v234, v234, v7
  v_xor_b32 v235, 96, v6
  v_add_u32 v235, v235, v7
  s_and_b32 s66, s63, 63
  v_and_b32 v6, 31, v0
  v_add_u32 v6, s66, v6
  v_lshrrev_b32 v7, 5, v0
  s_mul_i32 s68, s49, 14
  v_add_u32 v7, s68, v7
  v_lshlrev_b32 v7, 10, v7
  v_lshl_add_u32 v6, v6, 4, v7
  s_lshr_b32 s68, s63, 6
  s_mul_i32 s68, s68, 229376
  s_add_u32 s68, s68, 2097152
  s_add_u32 s88, s46, s68
  s_addc_u32 s89, s47, 0
  s_mov_b32 s69, 0xbfb8aa3b
  v_mov_b32 v136, 0
  v_mov_b32 v137, 0
  v_mov_b32 v138, 0
  v_mov_b32 v139, 0
  v_mov_b32 v140, 0
  v_mov_b32 v141, 0
  v_mov_b32 v142, 0
  v_mov_b32 v143, 0
  v_mov_b32 v144, 0
  v_mov_b32 v145, 0
  v_mov_b32 v146, 0
  v_mov_b32 v147, 0
  v_mov_b32 v148, 0
  v_mov_b32 v149, 0
  v_mov_b32 v150, 0
  v_mov_b32 v151, 0
  v_mov_b32 v152, 0
  v_mov_b32 v153, 0
  v_mov_b32 v154, 0
  v_mov_b32 v155, 0
  v_mov_b32 v156, 0
  v_mov_b32 v157, 0
  v_mov_b32 v158, 0
  v_mov_b32 v159, 0
  v_mov_b32 v160, 0
  v_mov_b32 v161, 0
  v_mov_b32 v162, 0
  v_mov_b32 v163, 0
  v_mov_b32 v164, 0
  v_mov_b32 v165, 0
  v_mov_b32 v166, 0
  v_mov_b32 v167, 0
  v_mov_b32 v168, 0
  v_mov_b32 v169, 0
  v_mov_b32 v170, 0
  v_mov_b32 v171, 0
  v_mov_b32 v172, 0
  v_mov_b32 v173, 0
  v_mov_b32 v174, 0
  v_mov_b32 v175, 0
  v_mov_b32 v176, 0
  v_mov_b32 v177, 0
  v_mov_b32 v178, 0
  v_mov_b32 v179, 0
  v_mov_b32 v180, 0
  v_mov_b32 v181, 0
  v_mov_b32 v182, 0
  v_mov_b32 v183, 0
  v_mov_b32 v184, 0
  v_mov_b32 v185, 0
  v_mov_b32 v186, 0
  v_mov_b32 v187, 0
  v_mov_b32 v188, 0
  v_mov_b32 v189, 0
  v_mov_b32 v190, 0
  v_mov_b32 v191, 0
  v_mov_b32 v192, 0
  v_mov_b32 v193, 0
  v_mov_b32 v194, 0
  v_mov_b32 v195, 0
  v_mov_b32 v196, 0
  v_mov_b32 v197, 0
  v_mov_b32 v198, 0
  v_mov_b32 v199, 0
  s_waitcnt vmcnt(10)
  s_barrier
  v_add_u32 v2, 0, v232
  v_add_u32 v3, 0, v233
  v_add_u32 v4, 0, v234
  v_add_u32 v5, 0, v235
  ds_read_b64_tr_b16 v[200:201], v2 offset:0
  ds_read_b64_tr_b16 v[202:203], v2 offset:512
  ds_read_b64_tr_b16 v[204:205], v3 offset:0
  ds_read_b64_tr_b16 v[206:207], v3 offset:512
  ds_read_b64_tr_b16 v[208:209], v4 offset:0
  ds_read_b64_tr_b16 v[210:211], v4 offset:512
  ds_read_b64_tr_b16 v[212:213], v5 offset:0
  ds_read_b64_tr_b16 v[214:215], v5 offset:512
  s_waitcnt lgkmcnt(4)
  ds_read_b64_tr_b16 v[216:217], v2 offset:2048
  ds_read_b64_tr_b16 v[218:219], v2 offset:2560
  ds_read_b64_tr_b16 v[220:221], v3 offset:2048
  ds_read_b64_tr_b16 v[222:223], v3 offset:2560
  ds_read_b64_tr_b16 v[224:225], v4 offset:2048
  ds_read_b64_tr_b16 v[226:227], v4 offset:2560
  ds_read_b64_tr_b16 v[228:229], v5 offset:2048
  ds_read_b64_tr_b16 v[230:231], v5 offset:2560
  s_waitcnt vmcnt(9)
  s_barrier
  v_add_u32 v2, 8192, v232
  v_add_u32 v3, 8192, v233
  v_add_u32 v4, 8192, v234
  v_add_u32 v5, 8192, v235
  s_waitcnt lgkmcnt(12)
  v_mfma_f32_32x32x16_bf16 v[136:151], v[200:203], v[8:11], v[136:151]
  ds_read_b64_tr_b16 v[200:201], v2 offset:0
  ds_read_b64_tr_b16 v[202:203], v2 offset:512
  s_add_u32 s61, s60, 917504
  s_add_u32 m0, s62, 65536
  s_nop 0
  buffer_load_dwordx4 v240, s[52:55], s61 offen lds
  s_waitcnt lgkmcnt(12)
  v_mfma_f32_32x32x16_bf16 v[152:167], v[204:207], v[8:11], v[152:167]
  ds_read_b64_tr_b16 v[204:205], v3 offset:0
  ds_read_b64_tr_b16 v[206:207], v3 offset:512
  s_add_u32 m0, s62, 69632
  s_nop 0
  buffer_load_dwordx4 v241, s[56:59], s61 offen lds
  s_waitcnt lgkmcnt(12)
  v_mfma_f32_32x32x16_bf16 v[168:183], v[208:211], v[8:11], v[168:183]
  ds_read_b64_tr_b16 v[208:209], v4 offset:0
  ds_read_b64_tr_b16 v[210:211], v4 offset:512
  s_add_u32 s61, s60, 1032192
  s_add_u32 m0, s62, 73728
  s_nop 0
  buffer_load_dwordx4 v240, s[52:55], s61 offen lds
  s_waitcnt lgkmcnt(12)
  v_mfma_f32_32x32x16_bf16 v[184:199], v[212:215], v[8:11], v[184:199]
  ds_read_b64_tr_b16 v[212:213], v5 offset:0
  ds_read_b64_tr_b16 v[214:215], v5 offset:512
  s_add_u32 m0, s62, 77824
  s_nop 0
  buffer_load_dwordx4 v241, s[56:59], s61 offen lds
  s_waitcnt lgkmcnt(12)
  v_mfma_f32_32x32x16_bf16 v[136:151], v[216:219], v[12:15], v[136:151]
  ds_read_b64_tr_b16 v[216:217], v2 offset:2048
  ds_read_b64_tr_b16 v[218:219], v2 offset:2560
  global_load_dwordx4 v[56:59], v1, s[64:65] sc1
  s_add_u32 s64, s64, 4096
  s_addc_u32 s65, s65, 0
  s_waitcnt lgkmcnt(12)
  v_mfma_f32_32x32x16_bf16 v[152:167], v[220:223], v[12:15], v[152:167]
  ds_read_b64_tr_b16 v[220:221], v3 offset:2048
  ds_read_b64_tr_b16 v[222:223], v3 offset:2560
  global_load_dwordx4 v[60:63], v1, s[64:65] sc1
  s_add_u32 s64, s64, 4096
  s_addc_u32 s65, s65, 0
  s_waitcnt lgkmcnt(12)
  v_mfma_f32_32x32x16_bf16 v[168:183], v[224:227], v[12:15], v[168:183]
  ds_read_b64_tr_b16 v[224:225], v4 offset:2048
  ds_read_b64_tr_b16 v[226:227], v4 offset:2560
  s_waitcnt lgkmcnt(12)
  v_mfma_f32_32x32x16_bf16 v[184:199], v[228:231], v[12:15], v[184:199]
  ds_read_b64_tr_b16 v[228:229], v5 offset:2048
  ds_read_b64_tr_b16 v[230:231], v5 offset:2560
  s_waitcnt vmcnt(13)
  v_add_u32 v2, 16384, v232
  v_add_u32 v3, 16384, v233
  v_add_u32 v4, 16384, v234
  v_add_u32 v5, 16384, v235
  s_waitcnt lgkmcnt(12)
  v_mfma_f32_32x32x16_bf16 v[136:151], v[200:203], v[16:19], v[136:151]
  ds_read_b64_tr_b16 v[200:201], v2 offset:0
  ds_read_b64_tr_b16 v[202:203], v2 offset:512
  global_load_dwordx4 v[64:67], v1, s[64:65] sc1
  s_add_u32 s64, s64, 4096
  s_addc_u32 s65, s65, 0
  s_waitcnt lgkmcnt(12)
  v_mfma_f32_32x32x16_bf16 v[152:167], v[204:207], v[16:19], v[152:167]
  ds_read_b64_tr_b16 v[204:205], v3 offset:0
  ds_read_b64_tr_b16 v[206:207], v3 offset:512
  global_load_dwordx4 v[68:71], v1, s[64:65] sc1
  s_add_u32 s64, s64, 4096
  s_addc_u32 s65, s65, 0
  s_waitcnt lgkmcnt(12)
  v_mfma_f32_32x32x16_bf16 v[168:183], v[208:211], v[16:19], v[168:183]
  ds_read_b64_tr_b16 v[208:209], v4 offset:0
  ds_read_b64_tr_b16 v[210:211], v4 offset:512
  s_waitcnt lgkmcnt(12)
  v_mfma_f32_32x32x16_bf16 v[184:199], v[212:215], v[16:19], v[184:199]
  ds_read_b64_tr_b16 v[212:213], v5 offset:0
  ds_read_b64_tr_b16 v[214:215], v5 offset:512
  s_waitcnt lgkmcnt(12)
  v_mfma_f32_32x32x16_bf16 v[136:151], v[216:219], v[20:23], v[136:151]
  ds_read_b64_tr_b16 v[216:217], v2 offset:2048
  ds_read_b64_tr_b16 v[218:219], v2 offset:2560
  s_waitcnt lgkmcnt(12)
  v_mfma_f32_32x32x16_bf16 v[152:167], v[220:223], v[20:23], v[152:167]
  ds_read_b64_tr_b16 v[220:221], v3 offset:2048
  ds_read_b64_tr_b16 v[222:223], v3 offset:2560
  s_waitcnt lgkmcnt(12)
  v_mfma_f32_32x32x16_bf16 v[168:183], v[224:227], v[20:23], v[168:183]
  ds_read_b64_tr_b16 v[224:225], v4 offset:2048
  ds_read_b64_tr_b16 v[226:227], v4 offset:2560
  s_waitcnt lgkmcnt(12)
  v_mfma_f32_32x32x16_bf16 v[184:199], v[228:231], v[20:23], v[184:199]
  ds_read_b64_tr_b16 v[228:229], v5 offset:2048
  ds_read_b64_tr_b16 v[230:231], v5 offset:2560
  s_waitcnt vmcnt(13)
  s_barrier
  v_add_u32 v2, 24576, v232
  v_add_u32 v3, 24576, v233
  v_add_u32 v4, 24576, v234
  v_add_u32 v5, 24576, v235
  s_waitcnt lgkmcnt(12)
  v_mfma_f32_32x32x16_bf16 v[136:151], v[200:203], v[24:27], v[136:151]
  ds_read_b64_tr_b16 v[200:201], v2 offset:0
  ds_read_b64_tr_b16 v[202:203], v2 offset:512
  s_add_u32 s61, s60, 1146880
  s_add_u32 m0, s62, 0
  s_nop 0
  buffer_load_dwordx4 v240, s[52:55], s61 offen lds
  s_waitcnt lgkmcnt(12)
  v_mfma_f32_32x32x16_bf16 v[152:167], v[204:207], v[24:27], v[152:167]
  ds_read_b64_tr_b16 v[204:205], v3 offset:0
  ds_read_b64_tr_b16 v[206:207], v3 offset:512
  s_add_u32 m0, s62, 4096
  s_nop 0
  buffer_load_dwordx4 v241, s[56:59], s61 offen lds
  s_waitcnt lgkmcnt(12)
  v_mfma_f32_32x32x16_bf16 v[168:183], v[208:211], v[24:27], v[168:183]
  ds_read_b64_tr_b16 v[208:209], v4 offset:0
  ds_read_b64_tr_b16 v[210:211], v4 offset:512
  s_add_u32 s61, s60, 1261568
  s_add_u32 m0, s62, 8192
  s_nop 0
  buffer_load_dwordx4 v240, s[52:55], s61 offen lds
  s_waitcnt lgkmcnt(12)
  v_mfma_f32_32x32x16_bf16 v[184:199], v[212:215], v[24:27], v[184:199]
  ds_read_b64_tr_b16 v[212:213], v5 offset:0
  ds_read_b64_tr_b16 v[214:215], v5 offset:512
  s_add_u32 m0, s62, 12288
  s_nop 0
  buffer_load_dwordx4 v241, s[56:59], s61 offen lds
  s_waitcnt lgkmcnt(12)
  v_mfma_f32_32x32x16_bf16 v[136:151], v[216:219], v[28:31], v[136:151]
  ds_read_b64_tr_b16 v[216:217], v2 offset:2048
  ds_read_b64_tr_b16 v[218:219], v2 offset:2560
  global_load_dwordx4 v[72:75], v1, s[64:65] sc1
  s_add_u32 s64, s64, 4096
  s_addc_u32 s65, s65, 0
  s_waitcnt lgkmcnt(12)
  v_mfma_f32_32x32x16_bf16 v[152:167], v[220:223], v[28:31], v[152:167]
  ds_read_b64_tr_b16 v[220:221], v3 offset:2048
  ds_read_b64_tr_b16 v[222:223], v3 offset:2560
  global_load_dwordx4 v[76:79], v1, s[64:65] sc1
  s_add_u32 s64, s64, 4096
  s_addc_u32 s65, s65, 0
  s_waitcnt lgkmcnt(12)
  v_mfma_f32_32x32x16_bf16 v[168:183], v[224:227], v[28:31], v[168:183]
  ds_read_b64_tr_b16 v[224:225], v4 offset:2048
  ds_read_b64_tr_b16 v[226:227], v4 offset:2560
  s_waitcnt lgkmcnt(12)
  v_mfma_f32_32x32x16_bf16 v[184:199], v[228:231], v[28:31], v[184:199]
  ds_read_b64_tr_b16 v[228:229], v5 offset:2048
  ds_read_b64_tr_b16 v[230:231], v5 offset:2560
  s_waitcnt vmcnt(17)
  v_add_u32 v2, 32768, v232
  v_add_u32 v3, 32768, v233
  v_add_u32 v4, 32768, v234
  v_add_u32 v5, 32768, v235
  s_waitcnt lgkmcnt(12)
  v_mfma_f32_32x32x16_bf16 v[136:151], v[200:203], v[32:35], v[136:151]
  ds_read_b64_tr_b16 v[200:201], v2 offset:0
  ds_read_b64_tr_b16 v[202:203], v2 offset:512
  global_load_dwordx4 v[80:83], v1, s[64:65] sc1
  s_add_u32 s64, s64, 4096
  s_addc_u32 s65, s65, 0
  s_waitcnt lgkmcnt(12)
  v_mfma_f32_32x32x16_bf16 v[152:167], v[204:207], v[32:35], v[152:167]
  ds_read_b64_tr_b16 v[204:205], v3 offset:0
  ds_read_b64_tr_b16 v[206:207], v3 offset:512
  global_load_dwordx4 v[84:87], v1, s[64:65] sc1
  s_add_u32 s64, s64, 4096
  s_addc_u32 s65, s65, 0
  s_waitcnt lgkmcnt(12)
  v_mfma_f32_32x32x16_bf16 v[168:183], v[208:211], v[32:35], v[168:183]
  ds_read_b64_tr_b16 v[208:209], v4 offset:0
  ds_read_b64_tr_b16 v[210:211], v4 offset:512
  s_waitcnt lgkmcnt(12)
  v_mfma_f32_32x32x16_bf16 v[184:199], v[212:215], v[32:35], v[184:199]
  ds_read_b64_tr_b16 v[212:213], v5 offset:0
  ds_read_b64_tr_b16 v[214:215], v5 offset:512
  s_waitcnt lgkmcnt(12)
  v_mfma_f32_32x32x16_bf16 v[136:151], v[216:219], v[36:39], v[136:151]
  ds_read_b64_tr_b16 v[216:217], v2 offset:2048
  ds_read_b64_tr_b16 v[218:219], v2 offset:2560
  s_waitcnt lgkmcnt(12)
  v_mfma_f32_32x32x16_bf16 v[152:167], v[220:223], v[36:39], v[152:167]
  ds_read_b64_tr_b16 v[220:221], v3 offset:2048
  ds_read_b64_tr_b16 v[222:223], v3 offset:2560
  s_waitcnt lgkmcnt(12)
  v_mfma_f32_32x32x16_bf16 v[168:183], v[224:227], v[36:39], v[168:183]
  ds_read_b64_tr_b16 v[224:225], v4 offset:2048
  ds_read_b64_tr_b16 v[226:227], v4 offset:2560
  s_waitcnt lgkmcnt(12)
  v_mfma_f32_32x32x16_bf16 v[184:199], v[228:231], v[36:39], v[184:199]
  ds_read_b64_tr_b16 v[228:229], v5 offset:2048
  ds_read_b64_tr_b16 v[230:231], v5 offset:2560
  s_waitcnt vmcnt(17)
  s_barrier
  v_add_u32 v2, 40960, v232
  v_add_u32 v3, 40960, v233
  v_add_u32 v4, 40960, v234
  v_add_u32 v5, 40960, v235
  s_waitcnt lgkmcnt(12)
  v_mfma_f32_32x32x16_bf16 v[136:151], v[200:203], v[40:43], v[136:151]
  ds_read_b64_tr_b16 v[200:201], v2 offset:0
  ds_read_b64_tr_b16 v[202:203], v2 offset:512
  s_add_u32 s61, s60, 1376256
  s_add_u32 m0, s62, 16384
  s_nop 0
  buffer_load_dwordx4 v240, s[52:55], s61 offen lds
  s_waitcnt lgkmcnt(12)
  v_mfma_f32_32x32x16_bf16 v[152:167], v[204:207], v[40:43], v[152:167]
  ds_read_b64_tr_b16 v[204:205], v3 offset:0
  ds_read_b64_tr_b16 v[206:207], v3 offset:512
  s_add_u32 m0, s62, 20480
  s_nop 0
  buffer_load_dwordx4 v241, s[56:59], s61 offen lds
  s_waitcnt lgkmcnt(12)
  v_mfma_f32_32x32x16_bf16 v[168:183], v[208:211], v[40:43], v[168:183]
  ds_read_b64_tr_b16 v[208:209], v4 offset:0
  ds_read_b64_tr_b16 v[210:211], v4 offset:512
  s_add_u32 s61, s60, 1490944
  s_add_u32 m0, s62, 24576
  s_nop 0
  buffer_load_dwordx4 v240, s[52:55], s61 offen lds
  s_waitcnt lgkmcnt(12)
  v_mfma_f32_32x32x16_bf16 v[184:199], v[212:215], v[40:43], v[184:199]
  ds_read_b64_tr_b16 v[212:213], v5 offset:0
  ds_read_b64_tr_b16 v[214:215], v5 offset:512
  s_add_u32 m0, s62, 28672
  s_nop 0
  buffer_load_dwordx4 v241, s[56:59], s61 offen lds
  s_waitcnt lgkmcnt(12)
  v_mfma_f32_32x32x16_bf16 v[136:151], v[216:219], v[44:47], v[136:151]
  ds_read_b64_tr_b16 v[216:217], v2 offset:2048
  ds_read_b64_tr_b16 v[218:219], v2 offset:2560
  global_load_dwordx4 v[88:91], v1, s[64:65] sc1
  s_add_u32 s64, s64, 4096
  s_addc_u32 s65, s65, 0
  s_waitcnt lgkmcnt(12)
  v_mfma_f32_32x32x16_bf16 v[152:167], v[220:223], v[44:47], v[152:167]
  ds_read_b64_tr_b16 v[220:221], v3 offset:2048
  ds_read_b64_tr_b16 v[222:223], v3 offset:2560
  global_load_dwordx4 v[92:95], v1, s[64:65] sc1
  s_add_u32 s64, s64, 4096
  s_addc_u32 s65, s65, 0
  s_waitcnt lgkmcnt(12)
  v_mfma_f32_32x32x16_bf16 v[168:183], v[224:227], v[44:47], v[168:183]
  ds_read_b64_tr_b16 v[224:225], v4 offset:2048
  ds_read_b64_tr_b16 v[226:227], v4 offset:2560
  s_waitcnt lgkmcnt(12)
  v_mfma_f32_32x32x16_bf16 v[184:199], v[228:231], v[44:47], v[184:199]
  ds_read_b64_tr_b16 v[228:229], v5 offset:2048
  ds_read_b64_tr_b16 v[230:231], v5 offset:2560
  s_waitcnt vmcnt(17)
  v_add_u32 v2, 49152, v232
  v_add_u32 v3, 49152, v233
  v_add_u32 v4, 49152, v234
  v_add_u32 v5, 49152, v235
  s_waitcnt lgkmcnt(12)
  v_mfma_f32_32x32x16_bf16 v[136:151], v[200:203], v[48:51], v[136:151]
  ds_read_b64_tr_b16 v[200:201], v2 offset:0
  ds_read_b64_tr_b16 v[202:203], v2 offset:512
  global_load_dwordx4 v[96:99], v1, s[64:65] sc1
  s_add_u32 s64, s64, 4096
  s_addc_u32 s65, s65, 0
  s_waitcnt lgkmcnt(12)
  v_mfma_f32_32x32x16_bf16 v[152:167], v[204:207], v[48:51], v[152:167]
  ds_read_b64_tr_b16 v[204:205], v3 offset:0
  ds_read_b64_tr_b16 v[206:207], v3 offset:512
  global_load_dwordx4 v[100:103], v1, s[64:65] sc1
  s_add_u32 s64, s64, 4096
  s_addc_u32 s65, s65, 0
  s_waitcnt lgkmcnt(12)
  v_mfma_f32_32x32x16_bf16 v[168:183], v[208:211], v[48:51], v[168:183]
  ds_read_b64_tr_b16 v[208:209], v4 offset:0
  ds_read_b64_tr_b16 v[210:211], v4 offset:512
  s_waitcnt lgkmcnt(12)
  v_mfma_f32_32x32x16_bf16 v[184:199], v[212:215], v[48:51], v[184:199]
  ds_read_b64_tr_b16 v[212:213], v5 offset:0
  ds_read_b64_tr_b16 v[214:215], v5 offset:512
  s_waitcnt lgkmcnt(12)
  v_mfma_f32_32x32x16_bf16 v[136:151], v[216:219], v[52:55], v[136:151]
  ds_read_b64_tr_b16 v[216:217], v2 offset:2048
  ds_read_b64_tr_b16 v[218:219], v2 offset:2560
  s_waitcnt lgkmcnt(12)
  v_mfma_f32_32x32x16_bf16 v[152:167], v[220:223], v[52:55], v[152:167]
  ds_read_b64_tr_b16 v[220:221], v3 offset:2048
  ds_read_b64_tr_b16 v[222:223], v3 offset:2560
  s_waitcnt lgkmcnt(12)
  v_mfma_f32_32x32x16_bf16 v[168:183], v[224:227], v[52:55], v[168:183]
  ds_read_b64_tr_b16 v[224:225], v4 offset:2048
  ds_read_b64_tr_b16 v[226:227], v4 offset:2560
  s_waitcnt lgkmcnt(12)
  v_mfma_f32_32x32x16_bf16 v[184:199], v[228:231], v[52:55], v[184:199]
  ds_read_b64_tr_b16 v[228:229], v5 offset:2048
  ds_read_b64_tr_b16 v[230:231], v5 offset:2560
  s_waitcnt vmcnt(17)
  s_barrier
  v_add_u32 v2, 57344, v232
  v_add_u32 v3, 57344, v233
  v_add_u32 v4, 57344, v234
  v_add_u32 v5, 57344, v235
  s_waitcnt lgkmcnt(12)
  v_mfma_f32_32x32x16_bf16 v[136:151], v[200:203], v[56:59], v[136:151]
  ds_read_b64_tr_b16 v[200:201], v2 offset:0
  ds_read_b64_tr_b16 v[202:203], v2 offset:512
  s_add_u32 s61, s60, 1605632
  s_add_u32 m0, s62, 32768
  s_nop 0
  buffer_load_dwordx4 v240, s[52:55], s61 offen lds
  s_waitcnt lgkmcnt(12)
  v_mfma_f32_32x32x16_bf16 v[152:167], v[204:207], v[56:59], v[152:167]
  ds_read_b64_tr_b16 v[204:205], v3 offset:0
  ds_read_b64_tr_b16 v[206:207], v3 offset:512
  s_add_u32 m0, s62, 36864
  s_nop 0
  buffer_load_dwordx4 v241, s[56:59], s61 offen lds
  s_waitcnt lgkmcnt(12)
  v_mfma_f32_32x32x16_bf16 v[168:183], v[208:211], v[56:59], v[168:183]
  ds_read_b64_tr_b16 v[208:209], v4 offset:0
  ds_read_b64_tr_b16 v[210:211], v4 offset:512
  s_add_u32 s61, s60, 1720320
  s_add_u32 m0, s62, 40960
  s_nop 0
  buffer_load_dwordx4 v240, s[52:55], s61 offen lds
  s_waitcnt lgkmcnt(12)
  v_mfma_f32_32x32x16_bf16 v[184:199], v[212:215], v[56:59], v[184:199]
  ds_read_b64_tr_b16 v[212:213], v5 offset:0
  ds_read_b64_tr_b16 v[214:215], v5 offset:512
  s_add_u32 m0, s62, 45056
  s_nop 0
  buffer_load_dwordx4 v241, s[56:59], s61 offen lds
  s_waitcnt lgkmcnt(12)
  v_mfma_f32_32x32x16_bf16 v[136:151], v[216:219], v[60:63], v[136:151]
  ds_read_b64_tr_b16 v[216:217], v2 offset:2048
  ds_read_b64_tr_b16 v[218:219], v2 offset:2560
  global_load_dwordx4 v[104:107], v1, s[64:65] sc1
  s_add_u32 s64, s64, 4096
  s_addc_u32 s65, s65, 0
  s_waitcnt lgkmcnt(12)
  v_mfma_f32_32x32x16_bf16 v[152:167], v[220:223], v[60:63], v[152:167]
  ds_read_b64_tr_b16 v[220:221], v3 offset:2048
  ds_read_b64_tr_b16 v[222:223], v3 offset:2560
  global_load_dwordx4 v[108:111], v1, s[64:65] sc1
  s_add_u32 s64, s64, 4096
  s_addc_u32 s65, s65, 0
  s_waitcnt lgkmcnt(12)
  v_mfma_f32_32x32x16_bf16 v[168:183], v[224:227], v[60:63], v[168:183]
  ds_read_b64_tr_b16 v[224:225], v4 offset:2048
  ds_read_b64_tr_b16 v[226:227], v4 offset:2560
  s_waitcnt lgkmcnt(12)
  v_mfma_f32_32x32x16_bf16 v[184:199], v[228:231], v[60:63], v[184:199]
  ds_read_b64_tr_b16 v[228:229], v5 offset:2048
  ds_read_b64_tr_b16 v[230:231], v5 offset:2560
  s_waitcnt vmcnt(17)
  v_add_u32 v2, 65536, v232
  v_add_u32 v3, 65536, v233
  v_add_u32 v4, 65536, v234
  v_add_u32 v5, 65536, v235
  s_waitcnt lgkmcnt(12)
  v_mfma_f32_32x32x16_bf16 v[136:151], v[200:203], v[64:67], v[136:151]
  ds_read_b64_tr_b16 v[200:201], v2 offset:0
  ds_read_b64_tr_b16 v[202:203], v2 offset:512
  global_load_dwordx4 v[112:115], v1, s[64:65] sc1
  s_add_u32 s64, s64, 4096
  s_addc_u32 s65, s65, 0
  s_waitcnt lgkmcnt(12)
  v_mfma_f32_32x32x16_bf16 v[152:167], v[204:207], v[64:67], v[152:167]
  ds_read_b64_tr_b16 v[204:205], v3 offset:0
  ds_read_b64_tr_b16 v[206:207], v3 offset:512
  global_load_dwordx4 v[116:119], v1, s[64:65] sc1
  s_add_u32 s64, s64, 4096
  s_addc_u32 s65, s65, 0
  s_waitcnt lgkmcnt(12)
  v_mfma_f32_32x32x16_bf16 v[168:183], v[208:211], v[64:67], v[168:183]
  ds_read_b64_tr_b16 v[208:209], v4 offset:0
  ds_read_b64_tr_b16 v[210:211], v4 offset:512
  s_waitcnt lgkmcnt(12)
  v_mfma_f32_32x32x16_bf16 v[184:199], v[212:215], v[64:67], v[184:199]
  ds_read_b64_tr_b16 v[212:213], v5 offset:0
  ds_read_b64_tr_b16 v[214:215], v5 offset:512
  s_waitcnt lgkmcnt(12)
  v_mfma_f32_32x32x16_bf16 v[136:151], v[216:219], v[68:71], v[136:151]
  ds_read_b64_tr_b16 v[216:217], v2 offset:2048
  ds_read_b64_tr_b16 v[218:219], v2 offset:2560
  s_waitcnt lgkmcnt(12)
  v_mfma_f32_32x32x16_bf16 v[152:167], v[220:223], v[68:71], v[152:167]
  ds_read_b64_tr_b16 v[220:221], v3 offset:2048
  ds_read_b64_tr_b16 v[222:223], v3 offset:2560
  s_waitcnt lgkmcnt(12)
  v_mfma_f32_32x32x16_bf16 v[168:183], v[224:227], v[68:71], v[168:183]
  ds_read_b64_tr_b16 v[224:225], v4 offset:2048
  ds_read_b64_tr_b16 v[226:227], v4 offset:2560
  s_waitcnt lgkmcnt(12)
  v_mfma_f32_32x32x16_bf16 v[184:199], v[228:231], v[68:71], v[184:199]
  ds_read_b64_tr_b16 v[228:229], v5 offset:2048
  ds_read_b64_tr_b16 v[230:231], v5 offset:2560
  s_waitcnt vmcnt(17)
  s_barrier
  v_add_u32 v2, 73728, v232
  v_add_u32 v3, 73728, v233
  v_add_u32 v4, 73728, v234
  v_add_u32 v5, 73728, v235
  s_waitcnt lgkmcnt(12)
  v_mfma_f32_32x32x16_bf16 v[136:151], v[200:203], v[72:75], v[136:151]
  ds_read_b64_tr_b16 v[200:201], v2 offset:0
  ds_read_b64_tr_b16 v[202:203], v2 offset:512
  s_add_u32 s61, s60, 128
  s_add_u32 m0, s62, 49152
  s_nop 0
  buffer_load_dwordx4 v240, s[52:55], s61 offen lds
  s_waitcnt lgkmcnt(12)
  v_mfma_f32_32x32x16_bf16 v[152:167], v[204:207], v[72:75], v[152:167]
  ds_read_b64_tr_b16 v[204:205], v3 offset:0
  ds_read_b64_tr_b16 v[206:207], v3 offset:512
  s_add_u32 m0, s62, 53248
  s_nop 0
  buffer_load_dwordx4 v241, s[56:59], s61 offen lds
  s_waitcnt lgkmcnt(12)
  v_mfma_f32_32x32x16_bf16 v[168:183], v[208:211], v[72:75], v[168:183]
  ds_read_b64_tr_b16 v[208:209], v4 offset:0
  ds_read_b64_tr_b16 v[210:211], v4 offset:512
  s_add_u32 s61, s60, 114816
  s_add_u32 m0, s62, 57344
  s_nop 0
  buffer_load_dwordx4 v240, s[52:55], s61 offen lds
  s_waitcnt lgkmcnt(12)
  v_mfma_f32_32x32x16_bf16 v[184:199], v[212:215], v[72:75], v[184:199]
  ds_read_b64_tr_b16 v[212:213], v5 offset:0
  ds_read_b64_tr_b16 v[214:215], v5 offset:512
  s_add_u32 m0, s62, 61440
  s_nop 0
  buffer_load_dwordx4 v241, s[56:59], s61 offen lds
  s_waitcnt lgkmcnt(12)
  v_mfma_f32_32x32x16_bf16 v[136:151], v[216:219], v[76:79], v[136:151]
  ds_read_b64_tr_b16 v[216:217], v2 offset:2048
  ds_read_b64_tr_b16 v[218:219], v2 offset:2560
  global_load_dwordx4 v[120:123], v1, s[64:65] sc1
  s_add_u32 s64, s64, 4096
  s_addc_u32 s65, s65, 0
  s_waitcnt lgkmcnt(12)
  v_mfma_f32_32x32x16_bf16 v[152:167], v[220:223], v[76:79], v[152:167]
  ds_read_b64_tr_b16 v[220:221], v3 offset:2048
  ds_read_b64_tr_b16 v[222:223], v3 offset:2560
  global_load_dwordx4 v[124:127], v1, s[64:65] sc1
  s_add_u32 s64, s64, 4096
  s_addc_u32 s65, s65, 0
  s_waitcnt lgkmcnt(12)
  v_mfma_f32_32x32x16_bf16 v[168:183], v[224:227], v[76:79], v[168:183]
  ds_read_b64_tr_b16 v[224:225], v4 offset:2048
  ds_read_b64_tr_b16 v[226:227], v4 offset:2560
  s_waitcnt lgkmcnt(12)
  v_mfma_f32_32x32x16_bf16 v[184:199], v[228:231], v[76:79], v[184:199]
  ds_read_b64_tr_b16 v[228:229], v5 offset:2048
  ds_read_b64_tr_b16 v[230:231], v5 offset:2560
  s_waitcnt vmcnt(17)
  v_add_u32 v2, 0, v232
  v_add_u32 v3, 0, v233
  v_add_u32 v4, 0, v234
  v_add_u32 v5, 0, v235
  s_waitcnt lgkmcnt(12)
  v_mfma_f32_32x32x16_bf16 v[136:151], v[200:203], v[80:83], v[136:151]
  ds_read_b64_tr_b16 v[200:201], v2 offset:0
  ds_read_b64_tr_b16 v[202:203], v2 offset:512
  global_load_dwordx4 v[128:131], v1, s[64:65] sc1
  s_add_u32 s64, s64, 4096
  s_addc_u32 s65, s65, 0
  s_waitcnt lgkmcnt(12)
  v_mfma_f32_32x32x16_bf16 v[152:167], v[204:207], v[80:83], v[152:167]
  ds_read_b64_tr_b16 v[204:205], v3 offset:0
  ds_read_b64_tr_b16 v[206:207], v3 offset:512
  global_load_dwordx4 v[132:135], v1, s[64:65] sc1
  s_add_u32 s64, s64, 4096
  s_addc_u32 s65, s65, 0
  s_waitcnt lgkmcnt(12)
  v_mfma_f32_32x32x16_bf16 v[168:183], v[208:211], v[80:83], v[168:183]
  ds_read_b64_tr_b16 v[208:209], v4 offset:0
  ds_read_b64_tr_b16 v[210:211], v4 offset:512
  s_waitcnt lgkmcnt(12)
  v_mfma_f32_32x32x16_bf16 v[184:199], v[212:215], v[80:83], v[184:199]
  ds_read_b64_tr_b16 v[212:213], v5 offset:0
  ds_read_b64_tr_b16 v[214:215], v5 offset:512
  s_waitcnt lgkmcnt(12)
  v_mfma_f32_32x32x16_bf16 v[136:151], v[216:219], v[84:87], v[136:151]
  ds_read_b64_tr_b16 v[216:217], v2 offset:2048
  ds_read_b64_tr_b16 v[218:219], v2 offset:2560
  s_waitcnt lgkmcnt(12)
  v_mfma_f32_32x32x16_bf16 v[152:167], v[220:223], v[84:87], v[152:167]
  ds_read_b64_tr_b16 v[220:221], v3 offset:2048
  ds_read_b64_tr_b16 v[222:223], v3 offset:2560
  s_waitcnt lgkmcnt(12)
  v_mfma_f32_32x32x16_bf16 v[168:183], v[224:227], v[84:87], v[168:183]
  ds_read_b64_tr_b16 v[224:225], v4 offset:2048
  ds_read_b64_tr_b16 v[226:227], v4 offset:2560
  s_waitcnt lgkmcnt(12)
  v_mfma_f32_32x32x16_bf16 v[184:199], v[228:231], v[84:87], v[184:199]
  ds_read_b64_tr_b16 v[228:229], v5 offset:2048
  ds_read_b64_tr_b16 v[230:231], v5 offset:2560
  s_waitcnt vmcnt(17)
  s_barrier
  v_add_u32 v2, 8192, v232
  v_add_u32 v3, 8192, v233
  v_add_u32 v4, 8192, v234
  v_add_u32 v5, 8192, v235
  s_waitcnt lgkmcnt(12)
  v_mfma_f32_32x32x16_bf16 v[136:151], v[200:203], v[88:91], v[136:151]
  ds_read_b64_tr_b16 v[200:201], v2 offset:0
  ds_read_b64_tr_b16 v[202:203], v2 offset:512
  s_add_u32 s61, s60, 229504
  s_add_u32 m0, s62, 65536
  s_nop 0
  buffer_load_dwordx4 v240, s[52:55], s61 offen lds
  s_waitcnt lgkmcnt(12)
  v_mfma_f32_32x32x16_bf16 v[152:167], v[204:207], v[88:91], v[152:167]
  ds_read_b64_tr_b16 v[204:205], v3 offset:0
  ds_read_b64_tr_b16 v[206:207], v3 offset:512
  s_add_u32 m0, s62, 69632
  s_nop 0
  buffer_load_dwordx4 v241, s[56:59], s61 offen lds
  s_waitcnt lgkmcnt(12)
  v_mfma_f32_32x32x16_bf16 v[168:183], v[208:211], v[88:91], v[168:183]
  ds_read_b64_tr_b16 v[208:209], v4 offset:0
  ds_read_b64_tr_b16 v[210:211], v4 offset:512
  s_add_u32 s61, s60, 344192
  s_add_u32 m0, s62, 73728
  s_nop 0
  buffer_load_dwordx4 v240, s[52:55], s61 offen lds
  s_waitcnt lgkmcnt(12)
  v_mfma_f32_32x32x16_bf16 v[184:199], v[212:215], v[88:91], v[184:199]
  ds_read_b64_tr_b16 v[212:213], v5 offset:0
  ds_read_b64_tr_b16 v[214:215], v5 offset:512
  s_add_u32 m0, s62, 77824
  s_nop 0
  buffer_load_dwordx4 v241, s[56:59], s61 offen lds
  s_waitcnt lgkmcnt(12)
  v_mfma_f32_32x32x16_bf16 v[136:151], v[216:219], v[92:95], v[136:151]
  ds_read_b64_tr_b16 v[216:217], v2 offset:2048
  ds_read_b64_tr_b16 v[218:219], v2 offset:2560
  s_waitcnt lgkmcnt(12)
  v_mfma_f32_32x32x16_bf16 v[152:167], v[220:223], v[92:95], v[152:167]
  ds_read_b64_tr_b16 v[220:221], v3 offset:2048
  ds_read_b64_tr_b16 v[222:223], v3 offset:2560
  s_waitcnt lgkmcnt(12)
  v_mfma_f32_32x32x16_bf16 v[168:183], v[224:227], v[92:95], v[168:183]
  ds_read_b64_tr_b16 v[224:225], v4 offset:2048
  ds_read_b64_tr_b16 v[226:227], v4 offset:2560
  s_waitcnt lgkmcnt(12)
  v_mfma_f32_32x32x16_bf16 v[184:199], v[228:231], v[92:95], v[184:199]
  ds_read_b64_tr_b16 v[228:229], v5 offset:2048
  ds_read_b64_tr_b16 v[230:231], v5 offset:2560
  s_waitcnt vmcnt(15)
  v_add_u32 v2, 16384, v232
  v_add_u32 v3, 16384, v233
  v_add_u32 v4, 16384, v234
  v_add_u32 v5, 16384, v235
  s_waitcnt lgkmcnt(12)
  v_mfma_f32_32x32x16_bf16 v[136:151], v[200:203], v[96:99], v[136:151]
  ds_read_b64_tr_b16 v[200:201], v2 offset:0
  ds_read_b64_tr_b16 v[202:203], v2 offset:512
  s_waitcnt lgkmcnt(12)
  v_mfma_f32_32x32x16_bf16 v[152:167], v[204:207], v[96:99], v[152:167]
  ds_read_b64_tr_b16 v[204:205], v3 offset:0
  ds_read_b64_tr_b16 v[206:207], v3 offset:512
  s_waitcnt lgkmcnt(12)
  v_mfma_f32_32x32x16_bf16 v[168:183], v[208:211], v[96:99], v[168:183]
  ds_read_b64_tr_b16 v[208:209], v4 offset:0
  ds_read_b64_tr_b16 v[210:211], v4 offset:512
  s_waitcnt lgkmcnt(12)
  v_mfma_f32_32x32x16_bf16 v[184:199], v[212:215], v[96:99], v[184:199]
  ds_read_b64_tr_b16 v[212:213], v5 offset:0
  ds_read_b64_tr_b16 v[214:215], v5 offset:512
  s_waitcnt lgkmcnt(12)
  v_mfma_f32_32x32x16_bf16 v[136:151], v[216:219], v[100:103], v[136:151]
  ds_read_b64_tr_b16 v[216:217], v2 offset:2048
  ds_read_b64_tr_b16 v[218:219], v2 offset:2560
  s_waitcnt lgkmcnt(12)
  v_mfma_f32_32x32x16_bf16 v[152:167], v[220:223], v[100:103], v[152:167]
  ds_read_b64_tr_b16 v[220:221], v3 offset:2048
  ds_read_b64_tr_b16 v[222:223], v3 offset:2560
  s_waitcnt lgkmcnt(12)
  v_mfma_f32_32x32x16_bf16 v[168:183], v[224:227], v[100:103], v[168:183]
  ds_read_b64_tr_b16 v[224:225], v4 offset:2048
  ds_read_b64_tr_b16 v[226:227], v4 offset:2560
  s_waitcnt lgkmcnt(12)
  v_mfma_f32_32x32x16_bf16 v[184:199], v[228:231], v[100:103], v[184:199]
  ds_read_b64_tr_b16 v[228:229], v5 offset:2048
  ds_read_b64_tr_b16 v[230:231], v5 offset:2560
  s_waitcnt vmcnt(13)
  s_barrier
  v_add_u32 v2, 24576, v232
  v_add_u32 v3, 24576, v233
  v_add_u32 v4, 24576, v234
  v_add_u32 v5, 24576, v235
  s_waitcnt lgkmcnt(12)
  v_mfma_f32_32x32x16_bf16 v[136:151], v[200:203], v[104:107], v[136:151]
  ds_read_b64_tr_b16 v[200:201], v2 offset:0
  ds_read_b64_tr_b16 v[202:203], v2 offset:512
  s_add_u32 s61, s60, 458880
  s_add_u32 m0, s62, 0
  s_nop 0
  buffer_load_dwordx4 v240, s[52:55], s61 offen lds
  s_waitcnt lgkmcnt(12)
  v_mfma_f32_32x32x16_bf16 v[152:167], v[204:207], v[104:107], v[152:167]
  ds_read_b64_tr_b16 v[204:205], v3 offset:0
  ds_read_b64_tr_b16 v[206:207], v3 offset:512
  s_add_u32 m0, s62, 4096
  s_nop 0
  buffer_load_dwordx4 v241, s[56:59], s61 offen lds
  s_waitcnt lgkmcnt(12)
  v_mfma_f32_32x32x16_bf16 v[168:183], v[208:211], v[104:107], v[168:183]
  ds_read_b64_tr_b16 v[208:209], v4 offset:0
  ds_read_b64_tr_b16 v[210:211], v4 offset:512
  s_add_u32 s61, s60, 573568
  s_add_u32 m0, s62, 8192
  s_nop 0
  buffer_load_dwordx4 v240, s[52:55], s61 offen lds
  s_waitcnt lgkmcnt(12)
  v_mfma_f32_32x32x16_bf16 v[184:199], v[212:215], v[104:107], v[184:199]
  ds_read_b64_tr_b16 v[212:213], v5 offset:0
  ds_read_b64_tr_b16 v[214:215], v5 offset:512
  s_add_u32 m0, s62, 12288
  s_nop 0
  buffer_load_dwordx4 v241, s[56:59], s61 offen lds
  s_waitcnt lgkmcnt(12)
  v_mfma_f32_32x32x16_bf16 v[136:151], v[216:219], v[108:111], v[136:151]
  ds_read_b64_tr_b16 v[216:217], v2 offset:2048
  ds_read_b64_tr_b16 v[218:219], v2 offset:2560
  s_waitcnt lgkmcnt(12)
  v_mfma_f32_32x32x16_bf16 v[152:167], v[220:223], v[108:111], v[152:167]
  ds_read_b64_tr_b16 v[220:221], v3 offset:2048
  ds_read_b64_tr_b16 v[222:223], v3 offset:2560
  s_waitcnt lgkmcnt(12)
  v_mfma_f32_32x32x16_bf16 v[168:183], v[224:227], v[108:111], v[168:183]
  ds_read_b64_tr_b16 v[224:225], v4 offset:2048
  ds_read_b64_tr_b16 v[226:227], v4 offset:2560
  s_waitcnt lgkmcnt(12)
  v_mfma_f32_32x32x16_bf16 v[184:199], v[228:231], v[108:111], v[184:199]
  ds_read_b64_tr_b16 v[228:229], v5 offset:2048
  ds_read_b64_tr_b16 v[230:231], v5 offset:2560
  s_waitcnt vmcnt(11)
  v_add_u32 v2, 32768, v232
  v_add_u32 v3, 32768, v233
  v_add_u32 v4, 32768, v234
  v_add_u32 v5, 32768, v235
  s_waitcnt lgkmcnt(12)
  v_mfma_f32_32x32x16_bf16 v[136:151], v[200:203], v[112:115], v[136:151]
  ds_read_b64_tr_b16 v[200:201], v2 offset:0
  ds_read_b64_tr_b16 v[202:203], v2 offset:512
  s_waitcnt lgkmcnt(12)
  v_mfma_f32_32x32x16_bf16 v[152:167], v[204:207], v[112:115], v[152:167]
  ds_read_b64_tr_b16 v[204:205], v3 offset:0
  ds_read_b64_tr_b16 v[206:207], v3 offset:512
  s_waitcnt lgkmcnt(12)
  v_mfma_f32_32x32x16_bf16 v[168:183], v[208:211], v[112:115], v[168:183]
  ds_read_b64_tr_b16 v[208:209], v4 offset:0
  ds_read_b64_tr_b16 v[210:211], v4 offset:512
  s_waitcnt lgkmcnt(12)
  v_mfma_f32_32x32x16_bf16 v[184:199], v[212:215], v[112:115], v[184:199]
  ds_read_b64_tr_b16 v[212:213], v5 offset:0
  ds_read_b64_tr_b16 v[214:215], v5 offset:512
  s_waitcnt lgkmcnt(12)
  v_mfma_f32_32x32x16_bf16 v[136:151], v[216:219], v[116:119], v[136:151]
  ds_read_b64_tr_b16 v[216:217], v2 offset:2048
  ds_read_b64_tr_b16 v[218:219], v2 offset:2560
  s_waitcnt lgkmcnt(12)
  v_mfma_f32_32x32x16_bf16 v[152:167], v[220:223], v[116:119], v[152:167]
  ds_read_b64_tr_b16 v[220:221], v3 offset:2048
  ds_read_b64_tr_b16 v[222:223], v3 offset:2560
  s_waitcnt lgkmcnt(12)
  v_mfma_f32_32x32x16_bf16 v[168:183], v[224:227], v[116:119], v[168:183]
  ds_read_b64_tr_b16 v[224:225], v4 offset:2048
  ds_read_b64_tr_b16 v[226:227], v4 offset:2560
  s_waitcnt lgkmcnt(12)
  v_mfma_f32_32x32x16_bf16 v[184:199], v[228:231], v[116:119], v[184:199]
  ds_read_b64_tr_b16 v[228:229], v5 offset:2048
  ds_read_b64_tr_b16 v[230:231], v5 offset:2560
  s_waitcnt vmcnt(9)
  s_barrier
  v_add_u32 v2, 40960, v232
  v_add_u32 v3, 40960, v233
  v_add_u32 v4, 40960, v234
  v_add_u32 v5, 40960, v235
  s_waitcnt lgkmcnt(12)
  v_mfma_f32_32x32x16_bf16 v[136:151], v[200:203], v[120:123], v[136:151]
  ds_read_b64_tr_b16 v[200:201], v2 offset:0
  ds_read_b64_tr_b16 v[202:203], v2 offset:512
  s_add_u32 s61, s60, 688256
  s_add_u32 m0, s62, 16384
  s_nop 0
  buffer_load_dwordx4 v240, s[52:55], s61 offen lds
  s_waitcnt lgkmcnt(12)
  v_mfma_f32_32x32x16_bf16 v[152:167], v[204:207], v[120:123], v[152:167]
  ds_read_b64_tr_b16 v[204:205], v3 offset:0
  ds_read_b64_tr_b16 v[206:207], v3 offset:512
  s_add_u32 m0, s62, 20480
  s_nop 0
  buffer_load_dwordx4 v241, s[56:59], s61 offen lds
  s_waitcnt lgkmcnt(12)
  v_mfma_f32_32x32x16_bf16 v[168:183], v[208:211], v[120:123], v[168:183]
  ds_read_b64_tr_b16 v[208:209], v4 offset:0
  ds_read_b64_tr_b16 v[210:211], v4 offset:512
  s_add_u32 s61, s60, 802944
  s_add_u32 m0, s62, 24576
  s_nop 0
  buffer_load_dwordx4 v240, s[52:55], s61 offen lds
  s_waitcnt lgkmcnt(12)
  v_mfma_f32_32x32x16_bf16 v[184:199], v[212:215], v[120:123], v[184:199]
  ds_read_b64_tr_b16 v[212:213], v5 offset:0
  ds_read_b64_tr_b16 v[214:215], v5 offset:512
  s_add_u32 m0, s62, 28672
  s_nop 0
  buffer_load_dwordx4 v241, s[56:59], s61 offen lds
  s_waitcnt lgkmcnt(12)
  v_mfma_f32_32x32x16_bf16 v[136:151], v[216:219], v[124:127], v[136:151]
  ds_read_b64_tr_b16 v[216:217], v2 offset:2048
  ds_read_b64_tr_b16 v[218:219], v2 offset:2560
  s_waitcnt lgkmcnt(12)
  v_mfma_f32_32x32x16_bf16 v[152:167], v[220:223], v[124:127], v[152:167]
  ds_read_b64_tr_b16 v[220:221], v3 offset:2048
  ds_read_b64_tr_b16 v[222:223], v3 offset:2560
  s_waitcnt lgkmcnt(12)
  v_mfma_f32_32x32x16_bf16 v[168:183], v[224:227], v[124:127], v[168:183]
  ds_read_b64_tr_b16 v[224:225], v4 offset:2048
  ds_read_b64_tr_b16 v[226:227], v4 offset:2560
  s_waitcnt lgkmcnt(12)
  v_mfma_f32_32x32x16_bf16 v[184:199], v[228:231], v[124:127], v[184:199]
  ds_read_b64_tr_b16 v[228:229], v5 offset:2048
  ds_read_b64_tr_b16 v[230:231], v5 offset:2560
  s_waitcnt vmcnt(12)
  s_waitcnt lgkmcnt(14)
  v_mfma_f32_32x32x16_bf16 v[136:151], v[200:203], v[128:131], v[136:151]
  s_waitcnt lgkmcnt(12)
  v_mfma_f32_32x32x16_bf16 v[152:167], v[204:207], v[128:131], v[152:167]
  s_waitcnt lgkmcnt(10)
  v_mfma_f32_32x32x16_bf16 v[168:183], v[208:211], v[128:131], v[168:183]
  s_waitcnt lgkmcnt(8)
  v_mfma_f32_32x32x16_bf16 v[184:199], v[212:215], v[128:131], v[184:199]
  s_waitcnt lgkmcnt(6)
  v_mfma_f32_32x32x16_bf16 v[136:151], v[216:219], v[132:135], v[136:151]
  s_waitcnt lgkmcnt(4)
  v_mfma_f32_32x32x16_bf16 v[152:167], v[220:223], v[132:135], v[152:167]
  s_waitcnt lgkmcnt(2)
  v_mfma_f32_32x32x16_bf16 v[168:183], v[224:227], v[132:135], v[168:183]
  s_waitcnt lgkmcnt(0)
  v_mfma_f32_32x32x16_bf16 v[184:199], v[228:231], v[132:135], v[184:199]
  s_nop 7
  s_nop 3
  v_cvt_pk_bf16_f32 v200, v136, v137
  v_cvt_pk_bf16_f32 v208, v138, v139
  v_cvt_pk_bf16_f32 v216, v140, v141
  v_cvt_pk_bf16_f32 v224, v142, v143
  v_cvt_pk_bf16_f32 v201, v144, v145
  v_cvt_pk_bf16_f32 v209, v146, v147
  v_cvt_pk_bf16_f32 v217, v148, v149
  v_cvt_pk_bf16_f32 v225, v150, v151
  v_lshlrev_b32 v202, 16, v200
  v_lshlrev_b32 v210, 16, v208
  v_lshlrev_b32 v218, 16, v216
  v_lshlrev_b32 v226, 16, v224
  v_and_b32 v203, 0xffff0000, v200
  v_and_b32 v211, 0xffff0000, v208
  v_and_b32 v219, 0xffff0000, v216
  v_and_b32 v227, 0xffff0000, v224
  v_mul_f32 v202, s69, v202
  v_mul_f32 v210, s69, v210
  v_mul_f32 v218, s69, v218
  v_mul_f32 v226, s69, v226
  v_mul_f32 v203, s69, v203
  v_mul_f32 v211, s69, v211
  v_mul_f32 v219, s69, v219
  v_mul_f32 v227, s69, v227
  v_exp_f32 v202, v202
  v_exp_f32 v210, v210
  v_exp_f32 v218, v218
  v_exp_f32 v226, v226
  v_exp_f32 v203, v203
  v_exp_f32 v211, v211
  v_exp_f32 v219, v219
  v_exp_f32 v227, v227
  v_lshlrev_b32 v204, 16, v201
  v_lshlrev_b32 v212, 16, v209
  v_lshlrev_b32 v220, 16, v217
  v_lshlrev_b32 v228, 16, v225
  v_and_b32 v205, 0xffff0000, v201
  v_and_b32 v213, 0xffff0000, v209
  v_and_b32 v221, 0xffff0000, v217
  v_and_b32 v229, 0xffff0000, v225
  v_add_f32 v202, 1.0, v202
  v_add_f32 v210, 1.0, v210
  v_add_f32 v218, 1.0, v218
  v_add_f32 v226, 1.0, v226
  v_add_f32 v203, 1.0, v203
  v_add_f32 v211, 1.0, v211
  v_add_f32 v219, 1.0, v219
  v_add_f32 v227, 1.0, v227
  v_rcp_f32 v202, v202
  v_rcp_f32 v210, v210
  v_rcp_f32 v218, v218
  v_rcp_f32 v226, v226
  v_rcp_f32 v203, v203
  v_rcp_f32 v211, v211
  v_rcp_f32 v219, v219
  v_rcp_f32 v227, v227
  v_cvt_pk_bf16_f32 v206, v202, v203
  v_cvt_pk_bf16_f32 v214, v210, v211
  v_cvt_pk_bf16_f32 v222, v218, v219
  v_cvt_pk_bf16_f32 v230, v226, v227
  v_lshlrev_b32 v202, 16, v206
  v_lshlrev_b32 v210, 16, v214
  v_lshlrev_b32 v218, 16, v222
  v_lshlrev_b32 v226, 16, v230
  v_and_b32 v203, 0xffff0000, v206
  v_and_b32 v211, 0xffff0000, v214
  v_and_b32 v219, 0xffff0000, v222
  v_and_b32 v227, 0xffff0000, v230
  v_pk_mul_f32 v[202:203], v[202:203], v[204:205]
  v_pk_mul_f32 v[210:211], v[210:211], v[212:213]
  v_pk_mul_f32 v[218:219], v[218:219], v[220:221]
  v_pk_mul_f32 v[226:227], v[226:227], v[228:229]
  v_cvt_pk_bf16_f32 v236, v202, v203
  v_cvt_pk_bf16_f32 v237, v210, v211
  v_cvt_pk_bf16_f32 v238, v218, v219
  v_cvt_pk_bf16_f32 v239, v226, v227
  s_nop 1
  v_permlane32_swap_b32 v236, v238
  v_permlane32_swap_b32 v237, v239
  global_store_dwordx4 v6, v[236:239], s[88:89] sc1
  s_add_u32 s88, s88, 2048
  s_addc_u32 s89, s89, 0
  v_cvt_pk_bf16_f32 v200, v152, v153
  v_cvt_pk_bf16_f32 v208, v154, v155
  v_cvt_pk_bf16_f32 v216, v156, v157
  v_cvt_pk_bf16_f32 v224, v158, v159
  v_cvt_pk_bf16_f32 v201, v160, v161
  v_cvt_pk_bf16_f32 v209, v162, v163
  v_cvt_pk_bf16_f32 v217, v164, v165
  v_cvt_pk_bf16_f32 v225, v166, v167
  v_lshlrev_b32 v202, 16, v200
  v_lshlrev_b32 v210, 16, v208
  v_lshlrev_b32 v218, 16, v216
  v_lshlrev_b32 v226, 16, v224
  v_and_b32 v203, 0xffff0000, v200
  v_and_b32 v211, 0xffff0000, v208
  v_and_b32 v219, 0xffff0000, v216
  v_and_b32 v227, 0xffff0000, v224
  v_mul_f32 v202, s69, v202
  v_mul_f32 v210, s69, v210
  v_mul_f32 v218, s69, v218
  v_mul_f32 v226, s69, v226
  v_mul_f32 v203, s69, v203
  v_mul_f32 v211, s69, v211
  v_mul_f32 v219, s69, v219
  v_mul_f32 v227, s69, v227
  v_exp_f32 v202, v202
  v_exp_f32 v210, v210
  v_exp_f32 v218, v218
  v_exp_f32 v226, v226
  v_exp_f32 v203, v203
  v_exp_f32 v211, v211
  v_exp_f32 v219, v219
  v_exp_f32 v227, v227
  v_lshlrev_b32 v204, 16, v201
  v_lshlrev_b32 v212, 16, v209
  v_lshlrev_b32 v220, 16, v217
  v_lshlrev_b32 v228, 16, v225
  v_and_b32 v205, 0xffff0000, v201
  v_and_b32 v213, 0xffff0000, v209
  v_and_b32 v221, 0xffff0000, v217
  v_and_b32 v229, 0xffff0000, v225
  v_add_f32 v202, 1.0, v202
  v_add_f32 v210, 1.0, v210
  v_add_f32 v218, 1.0, v218
  v_add_f32 v226, 1.0, v226
  v_add_f32 v203, 1.0, v203
  v_add_f32 v211, 1.0, v211
  v_add_f32 v219, 1.0, v219
  v_add_f32 v227, 1.0, v227
  v_rcp_f32 v202, v202
  v_rcp_f32 v210, v210
  v_rcp_f32 v218, v218
  v_rcp_f32 v226, v226
  v_rcp_f32 v203, v203
  v_rcp_f32 v211, v211
  v_rcp_f32 v219, v219
  v_rcp_f32 v227, v227
  v_cvt_pk_bf16_f32 v206, v202, v203
  v_cvt_pk_bf16_f32 v214, v210, v211
  v_cvt_pk_bf16_f32 v222, v218, v219
  v_cvt_pk_bf16_f32 v230, v226, v227
  v_lshlrev_b32 v202, 16, v206
  v_lshlrev_b32 v210, 16, v214
  v_lshlrev_b32 v218, 16, v222
  v_lshlrev_b32 v226, 16, v230
  v_and_b32 v203, 0xffff0000, v206
  v_and_b32 v211, 0xffff0000, v214
  v_and_b32 v219, 0xffff0000, v222
  v_and_b32 v227, 0xffff0000, v230
  v_pk_mul_f32 v[202:203], v[202:203], v[204:205]
  v_pk_mul_f32 v[210:211], v[210:211], v[212:213]
  v_pk_mul_f32 v[218:219], v[218:219], v[220:221]
  v_pk_mul_f32 v[226:227], v[226:227], v[228:229]
  v_cvt_pk_bf16_f32 v248, v202, v203
  v_cvt_pk_bf16_f32 v249, v210, v211
  v_cvt_pk_bf16_f32 v250, v218, v219
  v_cvt_pk_bf16_f32 v251, v226, v227
  s_nop 1
  v_permlane32_swap_b32 v248, v250
  v_permlane32_swap_b32 v249, v251
  global_store_dwordx4 v6, v[248:251], s[88:89] sc1
  s_add_u32 s88, s88, 2048
  s_addc_u32 s89, s89, 0
  v_cvt_pk_bf16_f32 v200, v168, v169
  v_cvt_pk_bf16_f32 v208, v170, v171
  v_cvt_pk_bf16_f32 v216, v172, v173
  v_cvt_pk_bf16_f32 v224, v174, v175
  v_cvt_pk_bf16_f32 v201, v176, v177
  v_cvt_pk_bf16_f32 v209, v178, v179
  v_cvt_pk_bf16_f32 v217, v180, v181
  v_cvt_pk_bf16_f32 v225, v182, v183
  v_lshlrev_b32 v202, 16, v200
  v_lshlrev_b32 v210, 16, v208
  v_lshlrev_b32 v218, 16, v216
  v_lshlrev_b32 v226, 16, v224
  v_and_b32 v203, 0xffff0000, v200
  v_and_b32 v211, 0xffff0000, v208
  v_and_b32 v219, 0xffff0000, v216
  v_and_b32 v227, 0xffff0000, v224
  v_mul_f32 v202, s69, v202
  v_mul_f32 v210, s69, v210
  v_mul_f32 v218, s69, v218
  v_mul_f32 v226, s69, v226
  v_mul_f32 v203, s69, v203
  v_mul_f32 v211, s69, v211
  v_mul_f32 v219, s69, v219
  v_mul_f32 v227, s69, v227
  v_exp_f32 v202, v202
  v_exp_f32 v210, v210
  v_exp_f32 v218, v218
  v_exp_f32 v226, v226
  v_exp_f32 v203, v203
  v_exp_f32 v211, v211
  v_exp_f32 v219, v219
  v_exp_f32 v227, v227
  v_lshlrev_b32 v204, 16, v201
  v_lshlrev_b32 v212, 16, v209
  v_lshlrev_b32 v220, 16, v217
  v_lshlrev_b32 v228, 16, v225
  v_and_b32 v205, 0xffff0000, v201
  v_and_b32 v213, 0xffff0000, v209
  v_and_b32 v221, 0xffff0000, v217
  v_and_b32 v229, 0xffff0000, v225
  v_add_f32 v202, 1.0, v202
  v_add_f32 v210, 1.0, v210
  v_add_f32 v218, 1.0, v218
  v_add_f32 v226, 1.0, v226
  v_add_f32 v203, 1.0, v203
  v_add_f32 v211, 1.0, v211
  v_add_f32 v219, 1.0, v219
  v_add_f32 v227, 1.0, v227
  v_rcp_f32 v202, v202
  v_rcp_f32 v210, v210
  v_rcp_f32 v218, v218
  v_rcp_f32 v226, v226
  v_rcp_f32 v203, v203
  v_rcp_f32 v211, v211
  v_rcp_f32 v219, v219
  v_rcp_f32 v227, v227
  v_cvt_pk_bf16_f32 v206, v202, v203
  v_cvt_pk_bf16_f32 v214, v210, v211
  v_cvt_pk_bf16_f32 v222, v218, v219
  v_cvt_pk_bf16_f32 v230, v226, v227
  v_lshlrev_b32 v202, 16, v206
  v_lshlrev_b32 v210, 16, v214
  v_lshlrev_b32 v218, 16, v222
  v_lshlrev_b32 v226, 16, v230
  v_and_b32 v203, 0xffff0000, v206
  v_and_b32 v211, 0xffff0000, v214
  v_and_b32 v219, 0xffff0000, v222
  v_and_b32 v227, 0xffff0000, v230
  v_pk_mul_f32 v[202:203], v[202:203], v[204:205]
  v_pk_mul_f32 v[210:211], v[210:211], v[212:213]
  v_pk_mul_f32 v[218:219], v[218:219], v[220:221]
  v_pk_mul_f32 v[226:227], v[226:227], v[228:229]
  v_cvt_pk_bf16_f32 v236, v202, v203
  v_cvt_pk_bf16_f32 v237, v210, v211
  v_cvt_pk_bf16_f32 v238, v218, v219
  v_cvt_pk_bf16_f32 v239, v226, v227
  s_nop 1
  v_permlane32_swap_b32 v236, v238
  v_permlane32_swap_b32 v237, v239
  global_store_dwordx4 v6, v[236:239], s[88:89] sc1
  s_add_u32 s88, s88, 2048
  s_addc_u32 s89, s89, 0
  v_cvt_pk_bf16_f32 v200, v184, v185
  v_cvt_pk_bf16_f32 v208, v186, v187
  v_cvt_pk_bf16_f32 v216, v188, v189
  v_cvt_pk_bf16_f32 v224, v190, v191
  v_cvt_pk_bf16_f32 v201, v192, v193
  v_cvt_pk_bf16_f32 v209, v194, v195
  v_cvt_pk_bf16_f32 v217, v196, v197
  v_cvt_pk_bf16_f32 v225, v198, v199
  v_lshlrev_b32 v202, 16, v200
  v_lshlrev_b32 v210, 16, v208
  v_lshlrev_b32 v218, 16, v216
  v_lshlrev_b32 v226, 16, v224
  v_and_b32 v203, 0xffff0000, v200
  v_and_b32 v211, 0xffff0000, v208
  v_and_b32 v219, 0xffff0000, v216
  v_and_b32 v227, 0xffff0000, v224
  v_mul_f32 v202, s69, v202
  v_mul_f32 v210, s69, v210
  v_mul_f32 v218, s69, v218
  v_mul_f32 v226, s69, v226
  v_mul_f32 v203, s69, v203
  v_mul_f32 v211, s69, v211
  v_mul_f32 v219, s69, v219
  v_mul_f32 v227, s69, v227
  v_exp_f32 v202, v202
  v_exp_f32 v210, v210
  v_exp_f32 v218, v218
  v_exp_f32 v226, v226
  v_exp_f32 v203, v203
  v_exp_f32 v211, v211
  v_exp_f32 v219, v219
  v_exp_f32 v227, v227
  v_lshlrev_b32 v204, 16, v201
  v_lshlrev_b32 v212, 16, v209
  v_lshlrev_b32 v220, 16, v217
  v_lshlrev_b32 v228, 16, v225
  v_and_b32 v205, 0xffff0000, v201
  v_and_b32 v213, 0xffff0000, v209
  v_and_b32 v221, 0xffff0000, v217
  v_and_b32 v229, 0xffff0000, v225
  v_add_f32 v202, 1.0, v202
  v_add_f32 v210, 1.0, v210
  v_add_f32 v218, 1.0, v218
  v_add_f32 v226, 1.0, v226
  v_add_f32 v203, 1.0, v203
  v_add_f32 v211, 1.0, v211
  v_add_f32 v219, 1.0, v219
  v_add_f32 v227, 1.0, v227
  v_rcp_f32 v202, v202
  v_rcp_f32 v210, v210
  v_rcp_f32 v218, v218
  v_rcp_f32 v226, v226
  v_rcp_f32 v203, v203
  v_rcp_f32 v211, v211
  v_rcp_f32 v219, v219
  v_rcp_f32 v227, v227
  v_cvt_pk_bf16_f32 v206, v202, v203
  v_cvt_pk_bf16_f32 v214, v210, v211
  v_cvt_pk_bf16_f32 v222, v218, v219
  v_cvt_pk_bf16_f32 v230, v226, v227
  v_lshlrev_b32 v202, 16, v206
  v_lshlrev_b32 v210, 16, v214
  v_lshlrev_b32 v218, 16, v222
  v_lshlrev_b32 v226, 16, v230
  v_and_b32 v203, 0xffff0000, v206
  v_and_b32 v211, 0xffff0000, v214
  v_and_b32 v219, 0xffff0000, v222
  v_and_b32 v227, 0xffff0000, v230
  v_pk_mul_f32 v[202:203], v[202:203], v[204:205]
  v_pk_mul_f32 v[210:211], v[210:211], v[212:213]
  v_pk_mul_f32 v[218:219], v[218:219], v[220:221]
  v_pk_mul_f32 v[226:227], v[226:227], v[228:229]
  v_cvt_pk_bf16_f32 v248, v202, v203
  v_cvt_pk_bf16_f32 v249, v210, v211
  v_cvt_pk_bf16_f32 v250, v218, v219
  v_cvt_pk_bf16_f32 v251, v226, v227
  s_nop 1
  v_permlane32_swap_b32 v248, v250
  v_permlane32_swap_b32 v249, v251
  global_store_dwordx4 v6, v[248:251], s[88:89] sc1
  s_add_u32 s88, s88, 2048
  s_addc_u32 s89, s89, 0
  v_mov_b32 v136, 0
  v_mov_b32 v137, 0
  v_mov_b32 v138, 0
  v_mov_b32 v139, 0
  v_mov_b32 v140, 0
  v_mov_b32 v141, 0
  v_mov_b32 v142, 0
  v_mov_b32 v143, 0
  v_mov_b32 v144, 0
  v_mov_b32 v145, 0
  v_mov_b32 v146, 0
  v_mov_b32 v147, 0
  v_mov_b32 v148, 0
  v_mov_b32 v149, 0
  v_mov_b32 v150, 0
  v_mov_b32 v151, 0
  v_mov_b32 v152, 0
  v_mov_b32 v153, 0
  v_mov_b32 v154, 0
  v_mov_b32 v155, 0
  v_mov_b32 v156, 0
  v_mov_b32 v157, 0
  v_mov_b32 v158, 0
  v_mov_b32 v159, 0
  v_mov_b32 v160, 0
  v_mov_b32 v161, 0
  v_mov_b32 v162, 0
  v_mov_b32 v163, 0
  v_mov_b32 v164, 0
  v_mov_b32 v165, 0
  v_mov_b32 v166, 0
  v_mov_b32 v167, 0
  v_mov_b32 v168, 0
  v_mov_b32 v169, 0
  v_mov_b32 v170, 0
  v_mov_b32 v171, 0
  v_mov_b32 v172, 0
  v_mov_b32 v173, 0
  v_mov_b32 v174, 0
  v_mov_b32 v175, 0
  v_mov_b32 v176, 0
  v_mov_b32 v177, 0
  v_mov_b32 v178, 0
  v_mov_b32 v179, 0
  v_mov_b32 v180, 0
  v_mov_b32 v181, 0
  v_mov_b32 v182, 0
  v_mov_b32 v183, 0
  s_waitcnt vmcnt(18)
  s_barrier
  v_add_u32 v2, 49152, v232
  v_add_u32 v3, 49152, v233
  v_add_u32 v4, 49152, v234
  ds_read_b64_tr_b16 v[200:201], v2 offset:0
  ds_read_b64_tr_b16 v[202:203], v2 offset:512
  ds_read_b64_tr_b16 v[204:205], v3 offset:0
  ds_read_b64_tr_b16 v[206:207], v3 offset:512
  ds_read_b64_tr_b16 v[208:209], v4 offset:0
  ds_read_b64_tr_b16 v[210:211], v4 offset:512
  s_waitcnt lgkmcnt(4)
  ds_read_b64_tr_b16 v[216:217], v2 offset:2048
  ds_read_b64_tr_b16 v[218:219], v2 offset:2560
  ds_read_b64_tr_b16 v[220:221], v3 offset:2048
  ds_read_b64_tr_b16 v[222:223], v3 offset:2560
  ds_read_b64_tr_b16 v[224:225], v4 offset:2048
  ds_read_b64_tr_b16 v[226:227], v4 offset:2560
  s_waitcnt vmcnt(10)
  s_barrier
  v_add_u32 v2, 57344, v232
  v_add_u32 v3, 57344, v233
  v_add_u32 v4, 57344, v234
  s_waitcnt lgkmcnt(8)
  v_mfma_f32_32x32x16_bf16 v[136:151], v[200:203], v[8:11], v[136:151]
  ds_read_b64_tr_b16 v[200:201], v2 offset:0
  ds_read_b64_tr_b16 v[202:203], v2 offset:512
  s_add_u32 s61, s60, 917632
  s_add_u32 m0, s62, 32768
  s_nop 0
  buffer_load_dwordx4 v240, s[52:55], s61 offen lds
  s_waitcnt lgkmcnt(8)
  v_mfma_f32_32x32x16_bf16 v[152:167], v[204:207], v[8:11], v[152:167]
  ds_read_b64_tr_b16 v[204:205], v3 offset:0
  ds_read_b64_tr_b16 v[206:207], v3 offset:512
  s_add_u32 m0, s62, 36864
  s_nop 0
  buffer_load_dwordx4 v241, s[56:59], s61 offen lds
  s_waitcnt lgkmcnt(8)
  v_mfma_f32_32x32x16_bf16 v[168:183], v[208:211], v[8:11], v[168:183]
  ds_read_b64_tr_b16 v[208:209], v4 offset:0
  ds_read_b64_tr_b16 v[210:211], v4 offset:512
  s_add_u32 s61, s60, 1032320
  s_add_u32 m0, s62, 40960
  s_nop 0
  buffer_load_dwordx4 v240, s[52:55], s61 offen lds
  s_waitcnt lgkmcnt(8)
  v_mfma_f32_32x32x16_bf16 v[136:151], v[216:219], v[12:15], v[136:151]
  ds_read_b64_tr_b16 v[216:217], v2 offset:2048
  ds_read_b64_tr_b16 v[218:219], v2 offset:2560
  s_add_u32 m0, s62, 45056
  s_nop 0
  buffer_load_dwordx4 v241, s[56:59], s61 offen lds
  s_waitcnt lgkmcnt(8)
  v_mfma_f32_32x32x16_bf16 v[152:167], v[220:223], v[12:15], v[152:167]
  ds_read_b64_tr_b16 v[220:221], v3 offset:2048
  ds_read_b64_tr_b16 v[222:223], v3 offset:2560
  s_waitcnt lgkmcnt(8)
  v_mfma_f32_32x32x16_bf16 v[168:183], v[224:227], v[12:15], v[168:183]
  ds_read_b64_tr_b16 v[224:225], v4 offset:2048
  ds_read_b64_tr_b16 v[226:227], v4 offset:2560
  v_add_u32 v2, 65536, v232
  v_add_u32 v3, 65536, v233
  v_add_u32 v4, 65536, v234
  s_waitcnt lgkmcnt(8)
  v_mfma_f32_32x32x16_bf16 v[136:151], v[200:203], v[16:19], v[136:151]
  ds_read_b64_tr_b16 v[200:201], v2 offset:0
  ds_read_b64_tr_b16 v[202:203], v2 offset:512
  s_waitcnt lgkmcnt(8)
  v_mfma_f32_32x32x16_bf16 v[152:167], v[204:207], v[16:19], v[152:167]
  ds_read_b64_tr_b16 v[204:205], v3 offset:0
  ds_read_b64_tr_b16 v[206:207], v3 offset:512
  s_waitcnt lgkmcnt(8)
  v_mfma_f32_32x32x16_bf16 v[168:183], v[208:211], v[16:19], v[168:183]
  ds_read_b64_tr_b16 v[208:209], v4 offset:0
  ds_read_b64_tr_b16 v[210:211], v4 offset:512
  s_waitcnt lgkmcnt(8)
  v_mfma_f32_32x32x16_bf16 v[136:151], v[216:219], v[20:23], v[136:151]
  ds_read_b64_tr_b16 v[216:217], v2 offset:2048
  ds_read_b64_tr_b16 v[218:219], v2 offset:2560
  s_waitcnt lgkmcnt(8)
  v_mfma_f32_32x32x16_bf16 v[152:167], v[220:223], v[20:23], v[152:167]
  ds_read_b64_tr_b16 v[220:221], v3 offset:2048
  ds_read_b64_tr_b16 v[222:223], v3 offset:2560
  s_waitcnt lgkmcnt(8)
  v_mfma_f32_32x32x16_bf16 v[168:183], v[224:227], v[20:23], v[168:183]
  ds_read_b64_tr_b16 v[224:225], v4 offset:2048
  ds_read_b64_tr_b16 v[226:227], v4 offset:2560
  s_waitcnt vmcnt(10)
  s_barrier
  v_add_u32 v2, 73728, v232
  v_add_u32 v3, 73728, v233
  v_add_u32 v4, 73728, v234
  s_waitcnt lgkmcnt(8)
  v_mfma_f32_32x32x16_bf16 v[136:151], v[200:203], v[24:27], v[136:151]
  ds_read_b64_tr_b16 v[200:201], v2 offset:0
  ds_read_b64_tr_b16 v[202:203], v2 offset:512
  s_add_u32 s61, s60, 1147008
  s_add_u32 m0, s62, 49152
  s_nop 0
  buffer_load_dwordx4 v240, s[52:55], s61 offen lds
  s_waitcnt lgkmcnt(8)
  v_mfma_f32_32x32x16_bf16 v[152:167], v[204:207], v[24:27], v[152:167]
  ds_read_b64_tr_b16 v[204:205], v3 offset:0
  ds_read_b64_tr_b16 v[206:207], v3 offset:512
  s_add_u32 m0, s62, 53248
  s_nop 0
  buffer_load_dwordx4 v241, s[56:59], s61 offen lds
  s_waitcnt lgkmcnt(8)
  v_mfma_f32_32x32x16_bf16 v[168:183], v[208:211], v[24:27], v[168:183]
  ds_read_b64_tr_b16 v[208:209], v4 offset:0
  ds_read_b64_tr_b16 v[210:211], v4 offset:512
  s_add_u32 s61, s60, 1261696
  s_add_u32 m0, s62, 57344
  s_nop 0
  buffer_load_dwordx4 v240, s[52:55], s61 offen lds
  s_waitcnt lgkmcnt(8)
  v_mfma_f32_32x32x16_bf16 v[136:151], v[216:219], v[28:31], v[136:151]
  ds_read_b64_tr_b16 v[216:217], v2 offset:2048
  ds_read_b64_tr_b16 v[218:219], v2 offset:2560
  s_add_u32 m0, s62, 61440
  s_nop 0
  buffer_load_dwordx4 v241, s[56:59], s61 offen lds
  s_waitcnt lgkmcnt(8)
  v_mfma_f32_32x32x16_bf16 v[152:167], v[220:223], v[28:31], v[152:167]
  ds_read_b64_tr_b16 v[220:221], v3 offset:2048
  ds_read_b64_tr_b16 v[222:223], v3 offset:2560
  s_waitcnt lgkmcnt(8)
  v_mfma_f32_32x32x16_bf16 v[168:183], v[224:227], v[28:31], v[168:183]
  ds_read_b64_tr_b16 v[224:225], v4 offset:2048
  ds_read_b64_tr_b16 v[226:227], v4 offset:2560
  v_add_u32 v2, 0, v232
  v_add_u32 v3, 0, v233
  v_add_u32 v4, 0, v234
  s_waitcnt lgkmcnt(8)
  v_mfma_f32_32x32x16_bf16 v[136:151], v[200:203], v[32:35], v[136:151]
  ds_read_b64_tr_b16 v[200:201], v2 offset:0
  ds_read_b64_tr_b16 v[202:203], v2 offset:512
  s_waitcnt lgkmcnt(8)
  v_mfma_f32_32x32x16_bf16 v[152:167], v[204:207], v[32:35], v[152:167]
  ds_read_b64_tr_b16 v[204:205], v3 offset:0
  ds_read_b64_tr_b16 v[206:207], v3 offset:512
  s_waitcnt lgkmcnt(8)
  v_mfma_f32_32x32x16_bf16 v[168:183], v[208:211], v[32:35], v[168:183]
  ds_read_b64_tr_b16 v[208:209], v4 offset:0
  ds_read_b64_tr_b16 v[210:211], v4 offset:512
  s_waitcnt lgkmcnt(8)
  v_mfma_f32_32x32x16_bf16 v[136:151], v[216:219], v[36:39], v[136:151]
  ds_read_b64_tr_b16 v[216:217], v2 offset:2048
  ds_read_b64_tr_b16 v[218:219], v2 offset:2560
  s_waitcnt lgkmcnt(8)
  v_mfma_f32_32x32x16_bf16 v[152:167], v[220:223], v[36:39], v[152:167]
  ds_read_b64_tr_b16 v[220:221], v3 offset:2048
  ds_read_b64_tr_b16 v[222:223], v3 offset:2560
  s_waitcnt lgkmcnt(8)
  v_mfma_f32_32x32x16_bf16 v[168:183], v[224:227], v[36:39], v[168:183]
  ds_read_b64_tr_b16 v[224:225], v4 offset:2048
  ds_read_b64_tr_b16 v[226:227], v4 offset:2560
  s_waitcnt vmcnt(10)
  s_barrier
  v_add_u32 v2, 8192, v232
  v_add_u32 v3, 8192, v233
  v_add_u32 v4, 8192, v234
  s_waitcnt lgkmcnt(8)
  v_mfma_f32_32x32x16_bf16 v[136:151], v[200:203], v[40:43], v[136:151]
  ds_read_b64_tr_b16 v[200:201], v2 offset:0
  ds_read_b64_tr_b16 v[202:203], v2 offset:512
  s_add_u32 s61, s60, 1376384
  s_add_u32 m0, s62, 65536
  s_nop 0
  buffer_load_dwordx4 v240, s[52:55], s61 offen lds
  s_waitcnt lgkmcnt(8)
  v_mfma_f32_32x32x16_bf16 v[152:167], v[204:207], v[40:43], v[152:167]
  ds_read_b64_tr_b16 v[204:205], v3 offset:0
  ds_read_b64_tr_b16 v[206:207], v3 offset:512
  s_add_u32 m0, s62, 69632
  s_nop 0
  buffer_load_dwordx4 v241, s[56:59], s61 offen lds
  s_waitcnt lgkmcnt(8)
  v_mfma_f32_32x32x16_bf16 v[168:183], v[208:211], v[40:43], v[168:183]
  ds_read_b64_tr_b16 v[208:209], v4 offset:0
  ds_read_b64_tr_b16 v[210:211], v4 offset:512
  s_add_u32 s61, s60, 1491072
  s_add_u32 m0, s62, 73728
  s_nop 0
  buffer_load_dwordx4 v240, s[52:55], s61 offen lds
  s_waitcnt lgkmcnt(8)
  v_mfma_f32_32x32x16_bf16 v[136:151], v[216:219], v[44:47], v[136:151]
  ds_read_b64_tr_b16 v[216:217], v2 offset:2048
  ds_read_b64_tr_b16 v[218:219], v2 offset:2560
  s_add_u32 m0, s62, 77824
  s_nop 0
  buffer_load_dwordx4 v241, s[56:59], s61 offen lds
  s_waitcnt lgkmcnt(8)
  v_mfma_f32_32x32x16_bf16 v[152:167], v[220:223], v[44:47], v[152:167]
  ds_read_b64_tr_b16 v[220:221], v3 offset:2048
  ds_read_b64_tr_b16 v[222:223], v3 offset:2560
  s_waitcnt lgkmcnt(8)
  v_mfma_f32_32x32x16_bf16 v[168:183], v[224:227], v[44:47], v[168:183]
  ds_read_b64_tr_b16 v[224:225], v4 offset:2048
  ds_read_b64_tr_b16 v[226:227], v4 offset:2560
  v_add_u32 v2, 16384, v232
  v_add_u32 v3, 16384, v233
  v_add_u32 v4, 16384, v234
  s_waitcnt lgkmcnt(8)
  v_mfma_f32_32x32x16_bf16 v[136:151], v[200:203], v[48:51], v[136:151]
  ds_read_b64_tr_b16 v[200:201], v2 offset:0
  ds_read_b64_tr_b16 v[202:203], v2 offset:512
  s_waitcnt lgkmcnt(8)
  v_mfma_f32_32x32x16_bf16 v[152:167], v[204:207], v[48:51], v[152:167]
  ds_read_b64_tr_b16 v[204:205], v3 offset:0
  ds_read_b64_tr_b16 v[206:207], v3 offset:512
  s_waitcnt lgkmcnt(8)
  v_mfma_f32_32x32x16_bf16 v[168:183], v[208:211], v[48:51], v[168:183]
  ds_read_b64_tr_b16 v[208:209], v4 offset:0
  ds_read_b64_tr_b16 v[210:211], v4 offset:512
  s_waitcnt lgkmcnt(8)
  v_mfma_f32_32x32x16_bf16 v[136:151], v[216:219], v[52:55], v[136:151]
  ds_read_b64_tr_b16 v[216:217], v2 offset:2048
  ds_read_b64_tr_b16 v[218:219], v2 offset:2560
  s_waitcnt lgkmcnt(8)
  v_mfma_f32_32x32x16_bf16 v[152:167], v[220:223], v[52:55], v[152:167]
  ds_read_b64_tr_b16 v[220:221], v3 offset:2048
  ds_read_b64_tr_b16 v[222:223], v3 offset:2560
  s_waitcnt lgkmcnt(8)
  v_mfma_f32_32x32x16_bf16 v[168:183], v[224:227], v[52:55], v[168:183]
  ds_read_b64_tr_b16 v[224:225], v4 offset:2048
  ds_read_b64_tr_b16 v[226:227], v4 offset:2560
  s_waitcnt vmcnt(0)
  s_barrier
  s_cmp_lg_u32 s50, 0
  s_cbranch_scc1 Lfs_9
  s_lshl_b32 s6, s48, 4
  s_add_u32 s6, s6, s49
  s_lshl_b32 s6, s6, 3
  s_add_u32 s6, s6, 12584960
  v_mov_b32 v244, s6
  v_mov_b32 v246, s8
  v_mov_b32 v247, s9
  s_mov_b64 s[6:7], exec
  s_mov_b64 exec, 1
  global_store_dwordx2 v244, v[246:247], s[46:47] sc1
  s_mov_b64 exec, s[6:7]
Lfs_9:
  v_add_u32 v2, 24576, v232
  v_add_u32 v3, 24576, v233
  v_add_u32 v4, 24576, v234
  s_waitcnt lgkmcnt(8)
  v_mfma_f32_32x32x16_bf16 v[136:151], v[200:203], v[56:59], v[136:151]
  ds_read_b64_tr_b16 v[200:201], v2 offset:0
  ds_read_b64_tr_b16 v[202:203], v2 offset:512
  s_add_u32 s61, s60, 1605760
  s_add_u32 m0, s62, 0
  s_nop 0
  buffer_load_dwordx4 v240, s[52:55], s61 offen lds
  s_waitcnt lgkmcnt(8)
  v_mfma_f32_32x32x16_bf16 v[152:167], v[204:207], v[56:59], v[152:167]
  ds_read_b64_tr_b16 v[204:205], v3 offset:0
  ds_read_b64_tr_b16 v[206:207], v3 offset:512
  s_add_u32 m0, s62, 4096
  s_nop 0
  buffer_load_dwordx4 v241, s[56:59], s61 offen lds
  s_waitcnt lgkmcnt(8)
  v_mfma_f32_32x32x16_bf16 v[168:183], v[208:211], v[56:59], v[168:183]
  ds_read_b64_tr_b16 v[208:209], v4 offset:0
  ds_read_b64_tr_b16 v[210:211], v4 offset:512
  s_add_u32 s61, s60, 1720448
  s_add_u32 m0, s62, 8192
  s_nop 0
  buffer_load_dwordx4 v240, s[52:55], s61 offen lds
  s_waitcnt lgkmcnt(8)
  v_mfma_f32_32x32x16_bf16 v[136:151], v[216:219], v[60:63], v[136:151]
  ds_read_b64_tr_b16 v[216:217], v2 offset:2048
  ds_read_b64_tr_b16 v[218:219], v2 offset:2560
  s_add_u32 m0, s62, 12288
  s_nop 0
  buffer_load_dwordx4 v241, s[56:59], s61 offen lds
  s_waitcnt lgkmcnt(8)
  v_mfma_f32_32x32x16_bf16 v[152:167], v[220:223], v[60:63], v[152:167]
  ds_read_b64_tr_b16 v[220:221], v3 offset:2048
  ds_read_b64_tr_b16 v[222:223], v3 offset:2560
  s_waitcnt lgkmcnt(8)
  v_mfma_f32_32x32x16_bf16 v[168:183], v[224:227], v[60:63], v[168:183]
  ds_read_b64_tr_b16 v[224:225], v4 offset:2048
  ds_read_b64_tr_b16 v[226:227], v4 offset:2560
  v_add_u32 v2, 32768, v232
  v_add_u32 v3, 32768, v233
  v_add_u32 v4, 32768, v234
  s_waitcnt lgkmcnt(8)
  v_mfma_f32_32x32x16_bf16 v[136:151], v[200:203], v[64:67], v[136:151]
  ds_read_b64_tr_b16 v[200:201], v2 offset:0
  ds_read_b64_tr_b16 v[202:203], v2 offset:512
  s_waitcnt lgkmcnt(8)
  v_mfma_f32_32x32x16_bf16 v[152:167], v[204:207], v[64:67], v[152:167]
  ds_read_b64_tr_b16 v[204:205], v3 offset:0
  ds_read_b64_tr_b16 v[206:207], v3 offset:512
  s_waitcnt lgkmcnt(8)
  v_mfma_f32_32x32x16_bf16 v[168:183], v[208:211], v[64:67], v[168:183]
  ds_read_b64_tr_b16 v[208:209], v4 offset:0
  ds_read_b64_tr_b16 v[210:211], v4 offset:512
  s_waitcnt lgkmcnt(8)
  v_mfma_f32_32x32x16_bf16 v[136:151], v[216:219], v[68:71], v[136:151]
  ds_read_b64_tr_b16 v[216:217], v2 offset:2048
  ds_read_b64_tr_b16 v[218:219], v2 offset:2560
  s_waitcnt lgkmcnt(8)
  v_mfma_f32_32x32x16_bf16 v[152:167], v[220:223], v[68:71], v[152:167]
  ds_read_b64_tr_b16 v[220:221], v3 offset:2048
  ds_read_b64_tr_b16 v[222:223], v3 offset:2560
  s_waitcnt lgkmcnt(8)
  v_mfma_f32_32x32x16_bf16 v[168:183], v[224:227], v[68:71], v[168:183]
  ds_read_b64_tr_b16 v[224:225], v4 offset:2048
  ds_read_b64_tr_b16 v[226:227], v4 offset:2560
  s_waitcnt vmcnt(10)
  s_barrier
  v_add_u32 v2, 40960, v232
  v_add_u32 v3, 40960, v233
  v_add_u32 v4, 40960, v234
  s_waitcnt lgkmcnt(8)
  v_mfma_f32_32x32x16_bf16 v[136:151], v[200:203], v[72:75], v[136:151]
  ds_read_b64_tr_b16 v[200:201], v2 offset:0
  ds_read_b64_tr_b16 v[202:203], v2 offset:512
  s_waitcnt lgkmcnt(8)
  v_mfma_f32_32x32x16_bf16 v[152:167], v[204:207], v[72:75], v[152:167]
  ds_read_b64_tr_b16 v[204:205], v3 offset:0
  ds_read_b64_tr_b16 v[206:207], v3 offset:512
  s_waitcnt lgkmcnt(8)
  v_mfma_f32_32x32x16_bf16 v[168:183], v[208:211], v[72:75], v[168:183]
  ds_read_b64_tr_b16 v[208:209], v4 offset:0
  ds_read_b64_tr_b16 v[210:211], v4 offset:512
  s_waitcnt lgkmcnt(8)
  v_mfma_f32_32x32x16_bf16 v[136:151], v[216:219], v[76:79], v[136:151]
  ds_read_b64_tr_b16 v[216:217], v2 offset:2048
  ds_read_b64_tr_b16 v[218:219], v2 offset:2560
  s_waitcnt lgkmcnt(8)
  v_mfma_f32_32x32x16_bf16 v[152:167], v[220:223], v[76:79], v[152:167]
  ds_read_b64_tr_b16 v[220:221], v3 offset:2048
  ds_read_b64_tr_b16 v[222:223], v3 offset:2560
  s_waitcnt lgkmcnt(8)
  v_mfma_f32_32x32x16_bf16 v[168:183], v[224:227], v[76:79], v[168:183]
  ds_read_b64_tr_b16 v[224:225], v4 offset:2048
  ds_read_b64_tr_b16 v[226:227], v4 offset:2560
  v_add_u32 v2, 49152, v232
  v_add_u32 v3, 49152, v233
  v_add_u32 v4, 49152, v234
  s_waitcnt lgkmcnt(8)
  v_mfma_f32_32x32x16_bf16 v[136:151], v[200:203], v[80:83], v[136:151]
  ds_read_b64_tr_b16 v[200:201], v2 offset:0
  ds_read_b64_tr_b16 v[202:203], v2 offset:512
  s_waitcnt lgkmcnt(8)
  v_mfma_f32_32x32x16_bf16 v[152:167], v[204:207], v[80:83], v[152:167]
  ds_read_b64_tr_b16 v[204:205], v3 offset:0
  ds_read_b64_tr_b16 v[206:207], v3 offset:512
  s_waitcnt lgkmcnt(8)
  v_mfma_f32_32x32x16_bf16 v[168:183], v[208:211], v[80:83], v[168:183]
  ds_read_b64_tr_b16 v[208:209], v4 offset:0
  ds_read_b64_tr_b16 v[210:211], v4 offset:512
  s_waitcnt lgkmcnt(8)
  v_mfma_f32_32x32x16_bf16 v[136:151], v[216:219], v[84:87], v[136:151]
  ds_read_b64_tr_b16 v[216:217], v2 offset:2048
  ds_read_b64_tr_b16 v[218:219], v2 offset:2560
  s_waitcnt lgkmcnt(8)
  v_mfma_f32_32x32x16_bf16 v[152:167], v[220:223], v[84:87], v[152:167]
  ds_read_b64_tr_b16 v[220:221], v3 offset:2048
  ds_read_b64_tr_b16 v[222:223], v3 offset:2560
  s_waitcnt lgkmcnt(8)
  v_mfma_f32_32x32x16_bf16 v[168:183], v[224:227], v[84:87], v[168:183]
  ds_read_b64_tr_b16 v[224:225], v4 offset:2048
  ds_read_b64_tr_b16 v[226:227], v4 offset:2560
  s_waitcnt vmcnt(6)
  s_barrier
  v_add_u32 v2, 57344, v232
  v_add_u32 v3, 57344, v233
  v_add_u32 v4, 57344, v234
  s_waitcnt lgkmcnt(8)
  v_mfma_f32_32x32x16_bf16 v[136:151], v[200:203], v[88:91], v[136:151]
  ds_read_b64_tr_b16 v[200:201], v2 offset:0
  ds_read_b64_tr_b16 v[202:203], v2 offset:512
  s_waitcnt lgkmcnt(8)
  v_mfma_f32_32x32x16_bf16 v[152:167], v[204:207], v[88:91], v[152:167]
  ds_read_b64_tr_b16 v[204:205], v3 offset:0
  ds_read_b64_tr_b16 v[206:207], v3 offset:512
  s_waitcnt lgkmcnt(8)
  v_mfma_f32_32x32x16_bf16 v[168:183], v[208:211], v[88:91], v[168:183]
  ds_read_b64_tr_b16 v[208:209], v4 offset:0
  ds_read_b64_tr_b16 v[210:211], v4 offset:512
  s_waitcnt lgkmcnt(8)
  v_mfma_f32_32x32x16_bf16 v[136:151], v[216:219], v[92:95], v[136:151]
  ds_read_b64_tr_b16 v[216:217], v2 offset:2048
  ds_read_b64_tr_b16 v[218:219], v2 offset:2560
  s_waitcnt lgkmcnt(8)
  v_mfma_f32_32x32x16_bf16 v[152:167], v[220:223], v[92:95], v[152:167]
  ds_read_b64_tr_b16 v[220:221], v3 offset:2048
  ds_read_b64_tr_b16 v[222:223], v3 offset:2560
  s_waitcnt lgkmcnt(8)
  v_mfma_f32_32x32x16_bf16 v[168:183], v[224:227], v[92:95], v[168:183]
  ds_read_b64_tr_b16 v[224:225], v4 offset:2048
  ds_read_b64_tr_b16 v[226:227], v4 offset:2560
  v_add_u32 v2, 65536, v232
  v_add_u32 v3, 65536, v233
  v_add_u32 v4, 65536, v234
  s_waitcnt lgkmcnt(8)
  v_mfma_f32_32x32x16_bf16 v[136:151], v[200:203], v[96:99], v[136:151]
  ds_read_b64_tr_b16 v[200:201], v2 offset:0
  ds_read_b64_tr_b16 v[202:203], v2 offset:512
  s_waitcnt lgkmcnt(8)
  v_mfma_f32_32x32x16_bf16 v[152:167], v[204:207], v[96:99], v[152:167]
  ds_read_b64_tr_b16 v[204:205], v3 offset:0
  ds_read_b64_tr_b16 v[206:207], v3 offset:512
  s_waitcnt lgkmcnt(8)
  v_mfma_f32_32x32x16_bf16 v[168:183], v[208:211], v[96:99], v[168:183]
  ds_read_b64_tr_b16 v[208:209], v4 offset:0
  ds_read_b64_tr_b16 v[210:211], v4 offset:512
  s_waitcnt lgkmcnt(8)
  v_mfma_f32_32x32x16_bf16 v[136:151], v[216:219], v[100:103], v[136:151]
  ds_read_b64_tr_b16 v[216:217], v2 offset:2048
  ds_read_b64_tr_b16 v[218:219], v2 offset:2560
  s_waitcnt lgkmcnt(8)
  v_mfma_f32_32x32x16_bf16 v[152:167], v[220:223], v[100:103], v[152:167]
  ds_read_b64_tr_b16 v[220:221], v3 offset:2048
  ds_read_b64_tr_b16 v[222:223], v3 offset:2560
  s_waitcnt lgkmcnt(8)
  v_mfma_f32_32x32x16_bf16 v[168:183], v[224:227], v[100:103], v[168:183]
  ds_read_b64_tr_b16 v[224:225], v4 offset:2048
  ds_read_b64_tr_b16 v[226:227], v4 offset:2560
  s_waitcnt vmcnt(2)
  s_barrier
  v_add_u32 v2, 73728, v232
  v_add_u32 v3, 73728, v233
  v_add_u32 v4, 73728, v234
  s_waitcnt lgkmcnt(8)
  v_mfma_f32_32x32x16_bf16 v[136:151], v[200:203], v[104:107], v[136:151]
  ds_read_b64_tr_b16 v[200:201], v2 offset:0
  ds_read_b64_tr_b16 v[202:203], v2 offset:512
  s_waitcnt lgkmcnt(8)
  v_mfma_f32_32x32x16_bf16 v[152:167], v[204:207], v[104:107], v[152:167]
  ds_read_b64_tr_b16 v[204:205], v3 offset:0
  ds_read_b64_tr_b16 v[206:207], v3 offset:512
  s_waitcnt lgkmcnt(8)
  v_mfma_f32_32x32x16_bf16 v[168:183], v[208:211], v[104:107], v[168:183]
  ds_read_b64_tr_b16 v[208:209], v4 offset:0
  ds_read_b64_tr_b16 v[210:211], v4 offset:512
  s_waitcnt lgkmcnt(8)
  v_mfma_f32_32x32x16_bf16 v[136:151], v[216:219], v[108:111], v[136:151]
  ds_read_b64_tr_b16 v[216:217], v2 offset:2048
  ds_read_b64_tr_b16 v[218:219], v2 offset:2560
  s_waitcnt lgkmcnt(8)
  v_mfma_f32_32x32x16_bf16 v[152:167], v[220:223], v[108:111], v[152:167]
  ds_read_b64_tr_b16 v[220:221], v3 offset:2048
  ds_read_b64_tr_b16 v[222:223], v3 offset:2560
  s_waitcnt lgkmcnt(8)
  v_mfma_f32_32x32x16_bf16 v[168:183], v[224:227], v[108:111], v[168:183]
  ds_read_b64_tr_b16 v[224:225], v4 offset:2048
  ds_read_b64_tr_b16 v[226:227], v4 offset:2560
  v_add_u32 v2, 0, v232
  v_add_u32 v3, 0, v233
  v_add_u32 v4, 0, v234
  s_waitcnt lgkmcnt(8)
  v_mfma_f32_32x32x16_bf16 v[136:151], v[200:203], v[112:115], v[136:151]
  ds_read_b64_tr_b16 v[200:201], v2 offset:0
  ds_read_b64_tr_b16 v[202:203], v2 offset:512
  s_waitcnt lgkmcnt(8)
  v_mfma_f32_32x32x16_bf16 v[152:167], v[204:207], v[112:115], v[152:167]
  ds_read_b64_tr_b16 v[204:205], v3 offset:0
  ds_read_b64_tr_b16 v[206:207], v3 offset:512
  s_waitcnt lgkmcnt(8)
  v_mfma_f32_32x32x16_bf16 v[168:183], v[208:211], v[112:115], v[168:183]
  ds_read_b64_tr_b16 v[208:209], v4 offset:0
  ds_read_b64_tr_b16 v[210:211], v4 offset:512
  s_waitcnt lgkmcnt(8)
  v_mfma_f32_32x32x16_bf16 v[136:151], v[216:219], v[116:119], v[136:151]
  ds_read_b64_tr_b16 v[216:217], v2 offset:2048
  ds_read_b64_tr_b16 v[218:219], v2 offset:2560
  s_waitcnt lgkmcnt(8)
  v_mfma_f32_32x32x16_bf16 v[152:167], v[220:223], v[116:119], v[152:167]
  ds_read_b64_tr_b16 v[220:221], v3 offset:2048
  ds_read_b64_tr_b16 v[222:223], v3 offset:2560
  s_waitcnt lgkmcnt(8)
  v_mfma_f32_32x32x16_bf16 v[168:183], v[224:227], v[116:119], v[168:183]
  ds_read_b64_tr_b16 v[224:225], v4 offset:2048
  ds_read_b64_tr_b16 v[226:227], v4 offset:2560
  s_waitcnt vmcnt(0)
  s_barrier
  v_add_u32 v2, 8192, v232
  v_add_u32 v3, 8192, v233
  v_add_u32 v4, 8192, v234
  s_waitcnt lgkmcnt(8)
  v_mfma_f32_32x32x16_bf16 v[136:151], v[200:203], v[120:123], v[136:151]
  ds_read_b64_tr_b16 v[200:201], v2 offset:0
  ds_read_b64_tr_b16 v[202:203], v2 offset:512
  s_waitcnt lgkmcnt(8)
  v_mfma_f32_32x32x16_bf16 v[152:167], v[204:207], v[120:123], v[152:167]
  ds_read_b64_tr_b16 v[204:205], v3 offset:0
  ds_read_b64_tr_b16 v[206:207], v3 offset:512
  s_waitcnt lgkmcnt(8)
  v_mfma_f32_32x32x16_bf16 v[168:183], v[208:211], v[120:123], v[168:183]
  ds_read_b64_tr_b16 v[208:209], v4 offset:0
  ds_read_b64_tr_b16 v[210:211], v4 offset:512
  s_waitcnt lgkmcnt(8)
  v_mfma_f32_32x32x16_bf16 v[136:151], v[216:219], v[124:127], v[136:151]
  ds_read_b64_tr_b16 v[216:217], v2 offset:2048
  ds_read_b64_tr_b16 v[218:219], v2 offset:2560
  s_waitcnt lgkmcnt(8)
  v_mfma_f32_32x32x16_bf16 v[152:167], v[220:223], v[124:127], v[152:167]
  ds_read_b64_tr_b16 v[220:221], v3 offset:2048
  ds_read_b64_tr_b16 v[222:223], v3 offset:2560
  s_waitcnt lgkmcnt(8)
  v_mfma_f32_32x32x16_bf16 v[168:183], v[224:227], v[124:127], v[168:183]
  ds_read_b64_tr_b16 v[224:225], v4 offset:2048
  ds_read_b64_tr_b16 v[226:227], v4 offset:2560
  s_waitcnt lgkmcnt(10)
  v_mfma_f32_32x32x16_bf16 v[136:151], v[200:203], v[128:131], v[136:151]
  s_waitcnt lgkmcnt(8)
  v_mfma_f32_32x32x16_bf16 v[152:167], v[204:207], v[128:131], v[152:167]
  s_waitcnt lgkmcnt(6)
  v_mfma_f32_32x32x16_bf16 v[168:183], v[208:211], v[128:131], v[168:183]
  s_waitcnt lgkmcnt(4)
  v_mfma_f32_32x32x16_bf16 v[136:151], v[216:219], v[132:135], v[136:151]
  s_waitcnt lgkmcnt(2)
  v_mfma_f32_32x32x16_bf16 v[152:167], v[220:223], v[132:135], v[152:167]
  s_waitcnt lgkmcnt(0)
  v_mfma_f32_32x32x16_bf16 v[168:183], v[224:227], v[132:135], v[168:183]
  s_barrier
  s_mov_b32 s52, s40
  s_and_b32 s53, s41, 0xffff
  s_mov_b32 s54, 1835008
  s_mov_b32 s55, 0x00020000
  s_lshr_b32 s80, s4, 1
  s_lshl_b32 s80, s80, 3
  s_and_b32 s81, s5, 7
  s_add_u32 s80, s80, s81
  s_and_b32 s81, s4, 1
  s_lshl_b32 s81, s81, 2
  s_lshr_b32 s82, s5, 3
  s_add_u32 s81, s81, s82
  s_lshr_b32 s90, s80, 1
  v_lshrrev_b32 v242, 3, v0
  v_bfe_u32 v243, v0, 1, 2
  v_and_b32 v238, 1, v0
  v_and_b32 v239, 2, v242
  v_xor_b32 v243, v243, v239
  v_lshlrev_b32 v242, 10, v242
  v_lshl_add_u32 v242, v238, 4, v242
  v_lshl_add_u32 v240, v243, 5, v242
  s_mul_i32 s84, s50, 458752
  s_lshl_b32 s85, s81, 7
  s_add_u32 s84, s84, s85
  s_mul_i32 s85, s50, 20480
  s_add_u32 s86, s84, 0
  s_add_u32 m0, s85, 0
  s_nop 0
  buffer_load_dwordx4 v240, s[52:55], s86 offen lds
  s_add_u32 s86, s84, 8192
  s_add_u32 m0, s85, 1024
  s_nop 0
  buffer_load_dwordx4 v240, s[52:55], s86 offen lds
  s_add_u32 s86, s84, 16384
  s_add_u32 m0, s85, 2048
  s_nop 0
  buffer_load_dwordx4 v240, s[52:55], s86 offen lds
  s_add_u32 s86, s84, 24576
  s_add_u32 m0, s85, 3072
  s_nop 0
  buffer_load_dwordx4 v240, s[52:55], s86 offen lds
  s_add_u32 s86, s84, 32768
  s_add_u32 m0, s85, 4096
  s_nop 0
  buffer_load_dwordx4 v240, s[52:55], s86 offen lds
  s_add_u32 s86, s84, 40960
  s_add_u32 m0, s85, 5120
  s_nop 0
  buffer_load_dwordx4 v240, s[52:55], s86 offen lds
  s_add_u32 s86, s84, 49152
  s_add_u32 m0, s85, 6144
  s_nop 0
  buffer_load_dwordx4 v240, s[52:55], s86 offen lds
  s_add_u32 s86, s84, 57344
  s_add_u32 m0, s85, 7168
  s_nop 0
  buffer_load_dwordx4 v240, s[52:55], s86 offen lds
  s_add_u32 s86, s84, 114688
  s_add_u32 m0, s85, 8192
  s_nop 0
  buffer_load_dwordx4 v240, s[52:55], s86 offen lds
  s_add_u32 s86, s84, 122880
  s_add_u32 m0, s85, 9216
  s_nop 0
  buffer_load_dwordx4 v240, s[52:55], s86 offen lds
  s_add_u32 s86, s84, 131072
  s_add_u32 m0, s85, 10240
  s_nop 0
  buffer_load_dwordx4 v240, s[52:55], s86 offen lds
  s_add_u32 s86, s84, 139264
  s_add_u32 m0, s85, 11264
  s_nop 0
  buffer_load_dwordx4 v240, s[52:55], s86 offen lds
  s_add_u32 s86, s84, 147456
  s_add_u32 m0, s85, 12288
  s_nop 0
  buffer_load_dwordx4 v240, s[52:55], s86 offen lds
  s_add_u32 s86, s84, 155648
  s_add_u32 m0, s85, 13312
  s_nop 0
  buffer_load_dwordx4 v240, s[52:55], s86 offen lds
  s_add_u32 s86, s84, 163840
  s_add_u32 m0, s85, 14336
  s_nop 0
  buffer_load_dwordx4 v240, s[52:55], s86 offen lds
  s_add_u32 s86, s84, 172032
  s_add_u32 m0, s85, 15360
  s_nop 0
  buffer_load_dwordx4 v240, s[52:55], s86 offen lds
  v_cvt_pk_bf16_f32 v200, v136, v137
  v_cvt_pk_bf16_f32 v208, v138, v139
  v_cvt_pk_bf16_f32 v216, v140, v141
  v_cvt_pk_bf16_f32 v224, v142, v143
  v_cvt_pk_bf16_f32 v201, v144, v145
  v_cvt_pk_bf16_f32 v209, v146, v147
  v_cvt_pk_bf16_f32 v217, v148, v149
  v_cvt_pk_bf16_f32 v225, v150, v151
  v_lshlrev_b32 v202, 16, v200
  v_lshlrev_b32 v210, 16, v208
  v_lshlrev_b32 v218, 16, v216
  v_lshlrev_b32 v226, 16, v224
  v_and_b32 v203, 0xffff0000, v200
  v_and_b32 v211, 0xffff0000, v208
  v_and_b32 v219, 0xffff0000, v216
  v_and_b32 v227, 0xffff0000, v224
  v_mul_f32 v202, s69, v202
  v_mul_f32 v210, s69, v210
  v_mul_f32 v218, s69, v218
  v_mul_f32 v226, s69, v226
  v_mul_f32 v203, s69, v203
  v_mul_f32 v211, s69, v211
  v_mul_f32 v219, s69, v219
  v_mul_f32 v227, s69, v227
  v_exp_f32 v202, v202
  v_exp_f32 v210, v210
  v_exp_f32 v218, v218
  v_exp_f32 v226, v226
  v_exp_f32 v203, v203
  v_exp_f32 v211, v211
  v_exp_f32 v219, v219
  v_exp_f32 v227, v227
  v_lshlrev_b32 v204, 16, v201
  v_lshlrev_b32 v212, 16, v209
  v_lshlrev_b32 v220, 16, v217
  v_lshlrev_b32 v228, 16, v225
  v_and_b32 v205, 0xffff0000, v201
  v_and_b32 v213, 0xffff0000, v209
  v_and_b32 v221, 0xffff0000, v217
  v_and_b32 v229, 0xffff0000, v225
  v_add_f32 v202, 1.0, v202
  v_add_f32 v210, 1.0, v210
  v_add_f32 v218, 1.0, v218
  v_add_f32 v226, 1.0, v226
  v_add_f32 v203, 1.0, v203
  v_add_f32 v211, 1.0, v211
  v_add_f32 v219, 1.0, v219
  v_add_f32 v227, 1.0, v227
  v_rcp_f32 v202, v202
  v_rcp_f32 v210, v210
  v_rcp_f32 v218, v218
  v_rcp_f32 v226, v226
  v_rcp_f32 v203, v203
  v_rcp_f32 v211, v211
  v_rcp_f32 v219, v219
  v_rcp_f32 v227, v227
  v_cvt_pk_bf16_f32 v206, v202, v203
  v_cvt_pk_bf16_f32 v214, v210, v211
  v_cvt_pk_bf16_f32 v222, v218, v219
  v_cvt_pk_bf16_f32 v230, v226, v227
  v_lshlrev_b32 v202, 16, v206
  v_lshlrev_b32 v210, 16, v214
  v_lshlrev_b32 v218, 16, v222
  v_lshlrev_b32 v226, 16, v230
  v_and_b32 v203, 0xffff0000, v206
  v_and_b32 v211, 0xffff0000, v214
  v_and_b32 v219, 0xffff0000, v222
  v_and_b32 v227, 0xffff0000, v230
  v_pk_mul_f32 v[202:203], v[202:203], v[204:205]
  v_pk_mul_f32 v[210:211], v[210:211], v[212:213]
  v_pk_mul_f32 v[218:219], v[218:219], v[220:221]
  v_pk_mul_f32 v[226:227], v[226:227], v[228:229]
  v_cvt_pk_bf16_f32 v236, v202, v203
  v_cvt_pk_bf16_f32 v237, v210, v211
  v_cvt_pk_bf16_f32 v238, v218, v219
  v_cvt_pk_bf16_f32 v239, v226, v227
  s_nop 1
  v_permlane32_swap_b32 v236, v238
  v_permlane32_swap_b32 v237, v239
  global_store_dwordx4 v6, v[236:239], s[88:89] sc1
  s_add_u32 s88, s88, 2048
  s_addc_u32 s89, s89, 0
  v_cvt_pk_bf16_f32 v200, v152, v153
  v_cvt_pk_bf16_f32 v208, v154, v155
  v_cvt_pk_bf16_f32 v216, v156, v157
  v_cvt_pk_bf16_f32 v224, v158, v159
  v_cvt_pk_bf16_f32 v201, v160, v161
  v_cvt_pk_bf16_f32 v209, v162, v163
  v_cvt_pk_bf16_f32 v217, v164, v165
  v_cvt_pk_bf16_f32 v225, v166, v167
  v_lshlrev_b32 v202, 16, v200
  v_lshlrev_b32 v210, 16, v208
  v_lshlrev_b32 v218, 16, v216
  v_lshlrev_b32 v226, 16, v224
  v_and_b32 v203, 0xffff0000, v200
  v_and_b32 v211, 0xffff0000, v208
  v_and_b32 v219, 0xffff0000, v216
  v_and_b32 v227, 0xffff0000, v224
  v_mul_f32 v202, s69, v202
  v_mul_f32 v210, s69, v210
  v_mul_f32 v218, s69, v218
  v_mul_f32 v226, s69, v226
  v_mul_f32 v203, s69, v203
  v_mul_f32 v211, s69, v211
  v_mul_f32 v219, s69, v219
  v_mul_f32 v227, s69, v227
  v_exp_f32 v202, v202
  v_exp_f32 v210, v210
  v_exp_f32 v218, v218
  v_exp_f32 v226, v226
  v_exp_f32 v203, v203
  v_exp_f32 v211, v211
  v_exp_f32 v219, v219
  v_exp_f32 v227, v227
  v_lshlrev_b32 v204, 16, v201
  v_lshlrev_b32 v212, 16, v209
  v_lshlrev_b32 v220, 16, v217
  v_lshlrev_b32 v228, 16, v225
  v_and_b32 v205, 0xffff0000, v201
  v_and_b32 v213, 0xffff0000, v209
  v_and_b32 v221, 0xffff0000, v217
  v_and_b32 v229, 0xffff0000, v225
  v_add_f32 v202, 1.0, v202
  v_add_f32 v210, 1.0, v210
  v_add_f32 v218, 1.0, v218
  v_add_f32 v226, 1.0, v226
  v_add_f32 v203, 1.0, v203
  v_add_f32 v211, 1.0, v211
  v_add_f32 v219, 1.0, v219
  v_add_f32 v227, 1.0, v227
  v_rcp_f32 v202, v202
  v_rcp_f32 v210, v210
  v_rcp_f32 v218, v218
  v_rcp_f32 v226, v226
  v_rcp_f32 v203, v203
  v_rcp_f32 v211, v211
  v_rcp_f32 v219, v219
  v_rcp_f32 v227, v227
  v_cvt_pk_bf16_f32 v206, v202, v203
  v_cvt_pk_bf16_f32 v214, v210, v211
  v_cvt_pk_bf16_f32 v222, v218, v219
  v_cvt_pk_bf16_f32 v230, v226, v227
  v_lshlrev_b32 v202, 16, v206
  v_lshlrev_b32 v210, 16, v214
  v_lshlrev_b32 v218, 16, v222
  v_lshlrev_b32 v226, 16, v230
  v_and_b32 v203, 0xffff0000, v206
  v_and_b32 v211, 0xffff0000, v214
  v_and_b32 v219, 0xffff0000, v222
  v_and_b32 v227, 0xffff0000, v230
  v_pk_mul_f32 v[202:203], v[202:203], v[204:205]
  v_pk_mul_f32 v[210:211], v[210:211], v[212:213]
  v_pk_mul_f32 v[218:219], v[218:219], v[220:221]
  v_pk_mul_f32 v[226:227], v[226:227], v[228:229]
  v_cvt_pk_bf16_f32 v248, v202, v203
  v_cvt_pk_bf16_f32 v249, v210, v211
  v_cvt_pk_bf16_f32 v250, v218, v219
  v_cvt_pk_bf16_f32 v251, v226, v227
  s_nop 1
  v_permlane32_swap_b32 v248, v250
  v_permlane32_swap_b32 v249, v251
  global_store_dwordx4 v6, v[248:251], s[88:89] sc1
  s_add_u32 s88, s88, 2048
  s_addc_u32 s89, s89, 0
  v_cvt_pk_bf16_f32 v200, v168, v169
  v_cvt_pk_bf16_f32 v208, v170, v171
  v_cvt_pk_bf16_f32 v216, v172, v173
  v_cvt_pk_bf16_f32 v224, v174, v175
  v_cvt_pk_bf16_f32 v201, v176, v177
  v_cvt_pk_bf16_f32 v209, v178, v179
  v_cvt_pk_bf16_f32 v217, v180, v181
  v_cvt_pk_bf16_f32 v225, v182, v183
  v_lshlrev_b32 v202, 16, v200
  v_lshlrev_b32 v210, 16, v208
  v_lshlrev_b32 v218, 16, v216
  v_lshlrev_b32 v226, 16, v224
  v_and_b32 v203, 0xffff0000, v200
  v_and_b32 v211, 0xffff0000, v208
  v_and_b32 v219, 0xffff0000, v216
  v_and_b32 v227, 0xffff0000, v224
  v_mul_f32 v202, s69, v202
  v_mul_f32 v210, s69, v210
  v_mul_f32 v218, s69, v218
  v_mul_f32 v226, s69, v226
  v_mul_f32 v203, s69, v203
  v_mul_f32 v211, s69, v211
  v_mul_f32 v219, s69, v219
  v_mul_f32 v227, s69, v227
  v_exp_f32 v202, v202
  v_exp_f32 v210, v210
  v_exp_f32 v218, v218
  v_exp_f32 v226, v226
  v_exp_f32 v203, v203
  v_exp_f32 v211, v211
  v_exp_f32 v219, v219
  v_exp_f32 v227, v227
  v_lshlrev_b32 v204, 16, v201
  v_lshlrev_b32 v212, 16, v209
  v_lshlrev_b32 v220, 16, v217
  v_lshlrev_b32 v228, 16, v225
  v_and_b32 v205, 0xffff0000, v201
  v_and_b32 v213, 0xffff0000, v209
  v_and_b32 v221, 0xffff0000, v217
  v_and_b32 v229, 0xffff0000, v225
  v_add_f32 v202, 1.0, v202
  v_add_f32 v210, 1.0, v210
  v_add_f32 v218, 1.0, v218
  v_add_f32 v226, 1.0, v226
  v_add_f32 v203, 1.0, v203
  v_add_f32 v211, 1.0, v211
  v_add_f32 v219, 1.0, v219
  v_add_f32 v227, 1.0, v227
  v_rcp_f32 v202, v202
  v_rcp_f32 v210, v210
  v_rcp_f32 v218, v218
  v_rcp_f32 v226, v226
  v_rcp_f32 v203, v203
  v_rcp_f32 v211, v211
  v_rcp_f32 v219, v219
  v_rcp_f32 v227, v227
  v_cvt_pk_bf16_f32 v206, v202, v203
  v_cvt_pk_bf16_f32 v214, v210, v211
  v_cvt_pk_bf16_f32 v222, v218, v219
  v_cvt_pk_bf16_f32 v230, v226, v227
  v_lshlrev_b32 v202, 16, v206
  v_lshlrev_b32 v210, 16, v214
  v_lshlrev_b32 v218, 16, v222
  v_lshlrev_b32 v226, 16, v230
  v_and_b32 v203, 0xffff0000, v206
  v_and_b32 v211, 0xffff0000, v214
  v_and_b32 v219, 0xffff0000, v222
  v_and_b32 v227, 0xffff0000, v230
  v_pk_mul_f32 v[202:203], v[202:203], v[204:205]
  v_pk_mul_f32 v[210:211], v[210:211], v[212:213]
  v_pk_mul_f32 v[218:219], v[218:219], v[220:221]
  v_pk_mul_f32 v[226:227], v[226:227], v[228:229]
  v_cvt_pk_bf16_f32 v236, v202, v203
  v_cvt_pk_bf16_f32 v237, v210, v211
  v_cvt_pk_bf16_f32 v238, v218, v219
  v_cvt_pk_bf16_f32 v239, v226, v227
  s_nop 1
  v_permlane32_swap_b32 v236, v238
  v_permlane32_swap_b32 v237, v239
  global_store_dwordx4 v6, v[236:239], s[88:89] sc1
  s_add_u32 s88, s88, 2048
  s_addc_u32 s89, s89, 0
  s_cmp_lg_u32 s50, 0
  s_cbranch_scc1 Lpl_10
  v_and_b32 v244, 15, v0
  v_lshlrev_b32 v244, 3, v244
  s_mul_i32 s6, s90, 128
  s_add_u32 s6, s6, 12584960
  v_add_u32 v244, s6, v244
  s_mov_b32 s6, 0
Lplp_11:
  global_load_dwordx2 v[246:247], v244, s[46:47] offset:0 sc1
  s_waitcnt vmcnt(0)
  v_xor_b32 v246, s8, v246
  v_xor_b32 v247, s9, v247
  v_or_b32 v246, v246, v247
  v_cmp_ne_u32 vcc, 0, v246
  s_add_u32 s6, s6, 1
  s_cmp_gt_u32 s6, 200000
  s_cbranch_scc1 Lpld_12
  s_cbranch_vccz Lpld_12
  s_sleep 4
  s_branch Lplp_11
Lpld_12:
Lpl_10:
  s_barrier
  s_waitcnt vmcnt(0)
  s_barrier
  s_cmp_lg_u32 s50, 0
  s_cbranch_scc1 Lfs_13
  s_lshl_b32 s6, s48, 4
  s_add_u32 s6, s6, s49
  s_lshl_b32 s6, s6, 3
  s_add_u32 s6, s6, 12589056
  v_mov_b32 v244, s6
  v_mov_b32 v246, s8
  v_mov_b32 v247, s9
  s_mov_b64 s[6:7], exec
  s_mov_b64 exec, 1
  global_store_dwordx2 v244, v[246:247], s[46:47] sc1
  s_mov_b64 exec, s[6:7]
Lfs_13:
  s_setprio 0
  v_and_b32 v1, 31, v0
  v_lshrrev_b32 v2, 5, v0
  s_mul_i32 s88, s50, 56
  v_add_u32 v2, s88, v2
  v_lshlrev_b32 v2, 10, v2
  v_lshl_add_u32 v1, v1, 4, v2
  s_mul_i32 s88, s80, 229376
  s_add_u32 s88, s88, 2097152
  s_add_u32 s92, s46, s88
  s_addc_u32 s93, s47, 0
  s_add_u32 s66, s92, 0
  s_addc_u32 s67, s93, 0
  global_load_dwordx4 v[104:107], v1, s[66:67] sc1
  global_load_dwordx4 v[108:111], v1, s[66:67] offset:512 sc1
  s_add_u32 s66, s92, 2048
  s_addc_u32 s67, s93, 0
  global_load_dwordx4 v[112:115], v1, s[66:67] sc1
  global_load_dwordx4 v[116:119], v1, s[66:67] offset:512 sc1
  s_add_u32 s66, s92, 4096
  s_addc_u32 s67, s93, 0
  global_load_dwordx4 v[120:123], v1, s[66:67] sc1
  global_load_dwordx4 v[124:127], v1, s[66:67] offset:512 sc1
  s_add_u32 s66, s92, 6144
  s_addc_u32 s67, s93, 0
  global_load_dwordx4 v[128:131], v1, s[66:67] sc1
  global_load_dwordx4 v[132:135], v1, s[66:67] offset:512 sc1
  s_add_u32 s66, s92, 14336
  s_addc_u32 s67, s93, 0
  global_load_dwordx4 v[136:139], v1, s[66:67] sc1
  global_load_dwordx4 v[140:143], v1, s[66:67] offset:512 sc1
  s_add_u32 s66, s92, 16384
  s_addc_u32 s67, s93, 0
  global_load_dwordx4 v[144:147], v1, s[66:67] sc1
  global_load_dwordx4 v[148:151], v1, s[66:67] offset:512 sc1
  s_add_u32 s66, s92, 18432
  s_addc_u32 s67, s93, 0
  global_load_dwordx4 v[152:155], v1, s[66:67] sc1
  global_load_dwordx4 v[156:159], v1, s[66:67] offset:512 sc1
  s_add_u32 s66, s92, 20480
  s_addc_u32 s67, s93, 0
  global_load_dwordx4 v[160:163], v1, s[66:67] sc1
  global_load_dwordx4 v[164:167], v1, s[66:67] offset:512 sc1
  s_and_b32 s82, s50, 1
  s_lshr_b32 s83, s50, 1
  s_lshl_b32 s87, s80, 6
  s_lshl_b32 s88, s82, 5
  s_add_u32 s87, s87, s88
  v_and_b32 v3, 31, v0
  v_add_u32 v3, s87, v3
  v_lshrrev_b32 v4, 5, v0
  s_lshl_b32 s88, s83, 5
  s_lshl_b32 s89, s81, 6
  s_add_u32 s88, s88, s89
  v_lshlrev_b32 v4, 2, v4
  v_add_u32 v4, s88, v4
  v_lshlrev_b32 v236, 10, v3
  v_lshl_add_u32 v236, v4, 1, v236
  v_lshlrev_b32 v237, 12, v4
  v_lshl_add_u32 v237, v3, 1, v237
  global_load_dwordx2 v[184:185], v236, s[16:17] offset:0
  global_load_dwordx2 v[186:187], v236, s[16:17] offset:16
  global_load_dwordx2 v[188:189], v236, s[16:17] offset:32
  global_load_dwordx2 v[190:191], v236, s[16:17] offset:48
  v_lshrrev_b32 v2, 4, v0
  v_and_b32 v3, 1, v2
  v_lshrrev_b32 v2, 1, v2
  v_bfe_u32 v4, v0, 2, 2
  v_and_b32 v5, 3, v0
  v_and_b32 v6, 2, v4
  v_lshl_add_u32 v7, v2, 3, v4
  v_lshlrev_b32 v7, 7, v7
  v_lshl_add_u32 v7, v5, 3, v7
  v_add_u32 v7, s85, v7
  v_add_u32 v2, 0, v3
  v_xor_b32 v2, v2, v6
  v_lshl_add_u32 v232, v2, 5, v7
  v_add_u32 v2, 2, v3
  v_xor_b32 v2, v2, v6
  v_lshl_add_u32 v233, v2, 5, v7
  v_mov_b32 v8, 0
  v_mov_b32 v9, 0
  v_mov_b32 v10, 0
  v_mov_b32 v11, 0
  v_mov_b32 v12, 0
  v_mov_b32 v13, 0
  v_mov_b32 v14, 0
  v_mov_b32 v15, 0
  v_mov_b32 v16, 0
  v_mov_b32 v17, 0
  v_mov_b32 v18, 0
  v_mov_b32 v19, 0
  v_mov_b32 v20, 0
  v_mov_b32 v21, 0
  v_mov_b32 v22, 0
  v_mov_b32 v23, 0
  v_mov_b32 v24, 0
  v_mov_b32 v25, 0
  v_mov_b32 v26, 0
  v_mov_b32 v27, 0
  v_mov_b32 v28, 0
  v_mov_b32 v29, 0
  v_mov_b32 v30, 0
  v_mov_b32 v31, 0
  v_mov_b32 v32, 0
  v_mov_b32 v33, 0
  v_mov_b32 v34, 0
  v_mov_b32 v35, 0
  v_mov_b32 v36, 0
  v_mov_b32 v37, 0
  v_mov_b32 v38, 0
  v_mov_b32 v39, 0
  v_mov_b32 v40, 0
  v_mov_b32 v41, 0
  v_mov_b32 v42, 0
  v_mov_b32 v43, 0
  v_mov_b32 v44, 0
  v_mov_b32 v45, 0
  v_mov_b32 v46, 0
  v_mov_b32 v47, 0
  v_mov_b32 v48, 0
  v_mov_b32 v49, 0
  v_mov_b32 v50, 0
  v_mov_b32 v51, 0
  v_mov_b32 v52, 0
  v_mov_b32 v53, 0
  v_mov_b32 v54, 0
  v_mov_b32 v55, 0
  v_mov_b32 v56, 0
  v_mov_b32 v57, 0
  v_mov_b32 v58, 0
  v_mov_b32 v59, 0
  v_mov_b32 v60, 0
  v_mov_b32 v61, 0
  v_mov_b32 v62, 0
  v_mov_b32 v63, 0
  v_mov_b32 v64, 0
  v_mov_b32 v65, 0
  v_mov_b32 v66, 0
  v_mov_b32 v67, 0
  v_mov_b32 v68, 0
  v_mov_b32 v69, 0
  v_mov_b32 v70, 0
  v_mov_b32 v71, 0
  s_waitcnt vmcnt(32)
  ds_read_b64_tr_b16 v[72:73], v232 offset:0
  ds_read_b64_tr_b16 v[74:75], v232 offset:512
  ds_read_b64_tr_b16 v[76:77], v233 offset:0
  ds_read_b64_tr_b16 v[78:79], v233 offset:512
  ds_read_b64_tr_b16 v[80:81], v232 offset:2048
  ds_read_b64_tr_b16 v[82:83], v232 offset:2560
  ds_read_b64_tr_b16 v[84:85], v233 offset:2048
  ds_read_b64_tr_b16 v[86:87], v233 offset:2560
  s_waitcnt vmcnt(18)
  s_waitcnt lgkmcnt(6)
  v_mfma_f32_32x32x16_bf16 v[8:23], v[72:75], v[104:107], v[8:23]
  ds_read_b64_tr_b16 v[88:89], v232 offset:4096
  ds_read_b64_tr_b16 v[90:91], v232 offset:4608
  v_mfma_f32_32x32x16_bf16 v[24:39], v[72:75], v[108:111], v[24:39]
  s_add_u32 s66, s92, 28672
  s_addc_u32 s67, s93, 0
  global_load_dwordx4 v[168:171], v1, s[66:67] sc1
  global_load_dwordx4 v[172:175], v1, s[66:67] offset:512 sc1
  s_waitcnt lgkmcnt(6)
  v_mfma_f32_32x32x16_bf16 v[40:55], v[76:79], v[104:107], v[40:55]
  ds_read_b64_tr_b16 v[92:93], v233 offset:4096
  ds_read_b64_tr_b16 v[94:95], v233 offset:4608
  v_mfma_f32_32x32x16_bf16 v[56:71], v[76:79], v[108:111], v[56:71]
  s_waitcnt vmcnt(18)
  s_waitcnt lgkmcnt(6)
  v_mfma_f32_32x32x16_bf16 v[8:23], v[80:83], v[112:115], v[8:23]
  ds_read_b64_tr_b16 v[96:97], v232 offset:6144
  ds_read_b64_tr_b16 v[98:99], v232 offset:6656
  v_mfma_f32_32x32x16_bf16 v[24:39], v[80:83], v[116:119], v[24:39]
  s_add_u32 s86, s84, 229376
  s_add_u32 m0, s85, 16384
  s_nop 0
  buffer_load_dwordx4 v240, s[52:55], s86 offen lds
  s_waitcnt lgkmcnt(6)
  v_mfma_f32_32x32x16_bf16 v[40:55], v[84:87], v[112:115], v[40:55]
  ds_read_b64_tr_b16 v[100:101], v233 offset:6144
  ds_read_b64_tr_b16 v[102:103], v233 offset:6656
  v_mfma_f32_32x32x16_bf16 v[56:71], v[84:87], v[116:119], v[56:71]
  s_add_u32 s86, s84, 237568
  s_add_u32 m0, s85, 17408
  s_nop 0
  buffer_load_dwordx4 v240, s[52:55], s86 offen lds
  s_add_u32 s66, s92, 30720
  s_addc_u32 s67, s93, 0
  global_load_dwordx4 v[176:179], v1, s[66:67] sc1
  global_load_dwordx4 v[180:183], v1, s[66:67] offset:512 sc1
  s_waitcnt vmcnt(20)
  s_waitcnt lgkmcnt(6)
  v_mfma_f32_32x32x16_bf16 v[8:23], v[88:91], v[120:123], v[8:23]
  ds_read_b64_tr_b16 v[72:73], v232 offset:8192
  ds_read_b64_tr_b16 v[74:75], v232 offset:8704
  v_mfma_f32_32x32x16_bf16 v[24:39], v[88:91], v[124:127], v[24:39]
  s_add_u32 s86, s84, 245760
  s_add_u32 m0, s85, 18432
  s_nop 0
  buffer_load_dwordx4 v240, s[52:55], s86 offen lds
  s_waitcnt lgkmcnt(6)
  v_mfma_f32_32x32x16_bf16 v[40:55], v[92:95], v[120:123], v[40:55]
  ds_read_b64_tr_b16 v[76:77], v233 offset:8192
  ds_read_b64_tr_b16 v[78:79], v233 offset:8704
  v_mfma_f32_32x32x16_bf16 v[56:71], v[92:95], v[124:127], v[56:71]
  s_add_u32 s86, s84, 253952
  s_add_u32 m0, s85, 19456
  s_nop 0
  buffer_load_dwordx4 v240, s[52:55], s86 offen lds
  s_add_u32 s66, s92, 32768
  s_addc_u32 s67, s93, 0
  global_load_dwordx4 v[104:107], v1, s[66:67] sc1
  global_load_dwordx4 v[108:111], v1, s[66:67] offset:512 sc1
  s_waitcnt vmcnt(22)
  s_waitcnt lgkmcnt(6)
  v_mfma_f32_32x32x16_bf16 v[8:23], v[96:99], v[128:131], v[8:23]
  ds_read_b64_tr_b16 v[80:81], v232 offset:10240
  ds_read_b64_tr_b16 v[82:83], v232 offset:10752
  v_mfma_f32_32x32x16_bf16 v[24:39], v[96:99], v[132:135], v[24:39]
  s_add_u32 s86, s84, 262144
  s_add_u32 m0, s85, 0
  s_nop 0
  buffer_load_dwordx4 v240, s[52:55], s86 offen lds
  s_waitcnt lgkmcnt(6)
  v_mfma_f32_32x32x16_bf16 v[40:55], v[100:103], v[128:131], v[40:55]
  ds_read_b64_tr_b16 v[84:85], v233 offset:10240
  ds_read_b64_tr_b16 v[86:87], v233 offset:10752
  v_mfma_f32_32x32x16_bf16 v[56:71], v[100:103], v[132:135], v[56:71]
  s_add_u32 s86, s84, 270336
  s_add_u32 m0, s85, 1024
  s_nop 0
  buffer_load_dwordx4 v240, s[52:55], s86 offen lds
  s_add_u32 s66, s92, 34816
  s_addc_u32 s67, s93, 0
  global_load_dwordx4 v[112:115], v1, s[66:67] sc1
  global_load_dwordx4 v[116:119], v1, s[66:67] offset:512 sc1
  s_waitcnt vmcnt(24)
  s_waitcnt lgkmcnt(6)
  v_mfma_f32_32x32x16_bf16 v[8:23], v[72:75], v[136:139], v[8:23]
  ds_read_b64_tr_b16 v[88:89], v232 offset:12288
  ds_read_b64_tr_b16 v[90:91], v232 offset:12800
  v_mfma_f32_32x32x16_bf16 v[24:39], v[72:75], v[140:143], v[24:39]
  s_add_u32 s86, s84, 278528
  s_add_u32 m0, s85, 2048
  s_nop 0
  buffer_load_dwordx4 v240, s[52:55], s86 offen lds
  s_waitcnt lgkmcnt(6)
  v_mfma_f32_32x32x16_bf16 v[40:55], v[76:79], v[136:139], v[40:55]
  ds_read_b64_tr_b16 v[92:93], v233 offset:12288
  ds_read_b64_tr_b16 v[94:95], v233 offset:12800
  v_mfma_f32_32x32x16_bf16 v[56:71], v[76:79], v[140:143], v[56:71]
  s_add_u32 s86, s84, 286720
  s_add_u32 m0, s85, 3072
  s_nop 0
  buffer_load_dwordx4 v240, s[52:55], s86 offen lds
  s_add_u32 s66, s92, 43008
  s_addc_u32 s67, s93, 0
  global_load_dwordx4 v[120:123], v1, s[66:67] sc1
  global_load_dwordx4 v[124:127], v1, s[66:67] offset:512 sc1
  s_waitcnt vmcnt(26)
  s_waitcnt lgkmcnt(6)
  v_mfma_f32_32x32x16_bf16 v[8:23], v[80:83], v[144:147], v[8:23]
  ds_read_b64_tr_b16 v[96:97], v232 offset:14336
  ds_read_b64_tr_b16 v[98:99], v232 offset:14848
  v_mfma_f32_32x32x16_bf16 v[24:39], v[80:83], v[148:151], v[24:39]
  s_add_u32 s86, s84, 344064
  s_add_u32 m0, s85, 4096
  s_nop 0
  buffer_load_dwordx4 v240, s[52:55], s86 offen lds
  s_waitcnt lgkmcnt(6)
  v_mfma_f32_32x32x16_bf16 v[40:55], v[84:87], v[144:147], v[40:55]
  ds_read_b64_tr_b16 v[100:101], v233 offset:14336
  ds_read_b64_tr_b16 v[102:103], v233 offset:14848
  v_mfma_f32_32x32x16_bf16 v[56:71], v[84:87], v[148:151], v[56:71]
  s_add_u32 s86, s84, 352256
  s_add_u32 m0, s85, 5120
  s_nop 0
  buffer_load_dwordx4 v240, s[52:55], s86 offen lds
  s_add_u32 s66, s92, 45056
  s_addc_u32 s67, s93, 0
  global_load_dwordx4 v[128:131], v1, s[66:67] sc1
  global_load_dwordx4 v[132:135], v1, s[66:67] offset:512 sc1
  s_waitcnt vmcnt(18)
  s_waitcnt lgkmcnt(6)
  v_mfma_f32_32x32x16_bf16 v[8:23], v[88:91], v[152:155], v[8:23]
  ds_read_b64_tr_b16 v[72:73], v232 offset:16384
  ds_read_b64_tr_b16 v[74:75], v232 offset:16896
  v_mfma_f32_32x32x16_bf16 v[24:39], v[88:91], v[156:159], v[24:39]
  s_add_u32 s86, s84, 360448
  s_add_u32 m0, s85, 6144
  s_nop 0
  buffer_load_dwordx4 v240, s[52:55], s86 offen lds
  s_waitcnt lgkmcnt(6)
  v_mfma_f32_32x32x16_bf16 v[40:55], v[92:95], v[152:155], v[40:55]
  ds_read_b64_tr_b16 v[76:77], v233 offset:16384
  ds_read_b64_tr_b16 v[78:79], v233 offset:16896
  v_mfma_f32_32x32x16_bf16 v[56:71], v[92:95], v[156:159], v[56:71]
  s_add_u32 s86, s84, 368640
  s_add_u32 m0, s85, 7168
  s_nop 0
  buffer_load_dwordx4 v240, s[52:55], s86 offen lds
  s_add_u32 s66, s92, 47104
  s_addc_u32 s67, s93, 0
  global_load_dwordx4 v[136:139], v1, s[66:67] sc1
  global_load_dwordx4 v[140:143], v1, s[66:67] offset:512 sc1
  s_waitcnt vmcnt(18)
  s_waitcnt lgkmcnt(6)
  v_mfma_f32_32x32x16_bf16 v[8:23], v[96:99], v[160:163], v[8:23]
  ds_read_b64_tr_b16 v[80:81], v232 offset:18432
  ds_read_b64_tr_b16 v[82:83], v232 offset:18944
  v_mfma_f32_32x32x16_bf16 v[24:39], v[96:99], v[164:167], v[24:39]
  s_add_u32 s86, s84, 376832
  s_add_u32 m0, s85, 8192
  s_nop 0
  buffer_load_dwordx4 v240, s[52:55], s86 offen lds
  s_waitcnt lgkmcnt(6)
  v_mfma_f32_32x32x16_bf16 v[40:55], v[100:103], v[160:163], v[40:55]
  ds_read_b64_tr_b16 v[84:85], v233 offset:18432
  ds_read_b64_tr_b16 v[86:87], v233 offset:18944
  v_mfma_f32_32x32x16_bf16 v[56:71], v[100:103], v[164:167], v[56:71]
  s_add_u32 s86, s84, 385024
  s_add_u32 m0, s85, 9216
  s_nop 0
  buffer_load_dwordx4 v240, s[52:55], s86 offen lds
  s_add_u32 s66, s92, 49152
  s_addc_u32 s67, s93, 0
  global_load_dwordx4 v[144:147], v1, s[66:67] sc1
  global_load_dwordx4 v[148:151], v1, s[66:67] offset:512 sc1
  s_cmp_lg_u32 s50, 0
  s_cbranch_scc1 Lpl_14
  v_and_b32 v244, 15, v0
  v_lshlrev_b32 v244, 3, v244
  s_mul_i32 s6, s90, 128
  s_add_u32 s6, s6, 12589056
  v_add_u32 v244, s6, v244
  s_mov_b32 s6, 0
Lplp_15:
  global_load_dwordx2 v[246:247], v244, s[46:47] offset:0 sc1
  s_waitcnt vmcnt(0)
  v_xor_b32 v246, s8, v246
  v_xor_b32 v247, s9, v247
  v_or_b32 v246, v246, v247
  v_cmp_ne_u32 vcc, 0, v246
  s_add_u32 s6, s6, 1
  s_cmp_gt_u32 s6, 200000
  s_cbranch_scc1 Lpld_16
  s_cbranch_vccz Lpld_16
  s_sleep 4
  s_branch Lplp_15
Lpld_16:
Lpl_14:
  s_barrier
  s_waitcnt vmcnt(18)
  s_waitcnt lgkmcnt(6)
  v_mfma_f32_32x32x16_bf16 v[8:23], v[72:75], v[168:171], v[8:23]
  ds_read_b64_tr_b16 v[88:89], v232 offset:0
  ds_read_b64_tr_b16 v[90:91], v232 offset:512
  v_mfma_f32_32x32x16_bf16 v[24:39], v[72:75], v[172:175], v[24:39]
  s_add_u32 s86, s84, 393216
  s_add_u32 m0, s85, 10240
  s_nop 0
  buffer_load_dwordx4 v240, s[52:55], s86 offen lds
  s_waitcnt lgkmcnt(6)
  v_mfma_f32_32x32x16_bf16 v[40:55], v[76:79], v[168:171], v[40:55]
  ds_read_b64_tr_b16 v[92:93], v233 offset:0
  ds_read_b64_tr_b16 v[94:95], v233 offset:512
  v_mfma_f32_32x32x16_bf16 v[56:71], v[76:79], v[172:175], v[56:71]
  s_add_u32 s86, s84, 401408
  s_add_u32 m0, s85, 11264
  s_nop 0
  buffer_load_dwordx4 v240, s[52:55], s86 offen lds
  s_add_u32 s66, s92, 8192
  s_addc_u32 s67, s93, 0
  global_load_dwordx4 v[152:155], v1, s[66:67] sc1
  global_load_dwordx4 v[156:159], v1, s[66:67] offset:512 sc1
  s_waitcnt vmcnt(18)
  s_waitcnt lgkmcnt(6)
  v_mfma_f32_32x32x16_bf16 v[8:23], v[80:83], v[176:179], v[8:23]
  ds_read_b64_tr_b16 v[96:97], v232 offset:2048
  ds_read_b64_tr_b16 v[98:99], v232 offset:2560
  v_mfma_f32_32x32x16_bf16 v[24:39], v[80:83], v[180:183], v[24:39]
  s_add_u32 s86, s84, 65536
  s_add_u32 m0, s85, 12288
  s_nop 0
  buffer_load_dwordx4 v240, s[52:55], s86 offen lds
  s_waitcnt lgkmcnt(6)
  v_mfma_f32_32x32x16_bf16 v[40:55], v[84:87], v[176:179], v[40:55]
  ds_read_b64_tr_b16 v[100:101], v233 offset:2048
  ds_read_b64_tr_b16 v[102:103], v233 offset:2560
  v_mfma_f32_32x32x16_bf16 v[56:71], v[84:87], v[180:183], v[56:71]
  s_add_u32 s86, s84, 73728
  s_add_u32 m0, s85, 13312
  s_nop 0
  buffer_load_dwordx4 v240, s[52:55], s86 offen lds
  s_add_u32 s66, s92, 10240
  s_addc_u32 s67, s93, 0
  global_load_dwordx4 v[160:163], v1, s[66:67] sc1
  global_load_dwordx4 v[164:167], v1, s[66:67] offset:512 sc1
  s_waitcnt vmcnt(18)
  s_waitcnt lgkmcnt(6)
  v_mfma_f32_32x32x16_bf16 v[8:23], v[88:91], v[104:107], v[8:23]
  ds_read_b64_tr_b16 v[72:73], v232 offset:4096
  ds_read_b64_tr_b16 v[74:75], v232 offset:4608
  v_mfma_f32_32x32x16_bf16 v[24:39], v[88:91], v[108:111], v[24:39]
  s_add_u32 s86, s84, 81920
  s_add_u32 m0, s85, 14336
  s_nop 0
  buffer_load_dwordx4 v240, s[52:55], s86 offen lds
  s_waitcnt lgkmcnt(6)
  v_mfma_f32_32x32x16_bf16 v[40:55], v[92:95], v[104:107], v[40:55]
  ds_read_b64_tr_b16 v[76:77], v233 offset:4096
  ds_read_b64_tr_b16 v[78:79], v233 offset:4608
  v_mfma_f32_32x32x16_bf16 v[56:71], v[92:95], v[108:111], v[56:71]
  s_add_u32 s86, s84, 90112
  s_add_u32 m0, s85, 15360
  s_nop 0
  buffer_load_dwordx4 v240, s[52:55], s86 offen lds
  s_add_u32 s66, s92, 12288
  s_addc_u32 s67, s93, 0
  global_load_dwordx4 v[168:171], v1, s[66:67] sc1
  global_load_dwordx4 v[172:175], v1, s[66:67] offset:512 sc1
  s_waitcnt vmcnt(18)
  s_waitcnt lgkmcnt(6)
  v_mfma_f32_32x32x16_bf16 v[8:23], v[96:99], v[112:115], v[8:23]
  ds_read_b64_tr_b16 v[80:81], v232 offset:6144
  ds_read_b64_tr_b16 v[82:83], v232 offset:6656
  v_mfma_f32_32x32x16_bf16 v[24:39], v[96:99], v[116:119], v[24:39]
  s_add_u32 s86, s84, 98304
  s_add_u32 m0, s85, 16384
  s_nop 0
  buffer_load_dwordx4 v240, s[52:55], s86 offen lds
  s_waitcnt lgkmcnt(6)
  v_mfma_f32_32x32x16_bf16 v[40:55], v[100:103], v[112:115], v[40:55]
  ds_read_b64_tr_b16 v[84:85], v233 offset:6144
  ds_read_b64_tr_b16 v[86:87], v233 offset:6656
  v_mfma_f32_32x32x16_bf16 v[56:71], v[100:103], v[116:119], v[56:71]
  s_add_u32 s86, s84, 106496
  s_add_u32 m0, s85, 17408
  s_nop 0
  buffer_load_dwordx4 v240, s[52:55], s86 offen lds
  s_add_u32 s66, s92, 22528
  s_addc_u32 s67, s93, 0
  global_load_dwordx4 v[176:179], v1, s[66:67] sc1
  global_load_dwordx4 v[180:183], v1, s[66:67] offset:512 sc1
  s_waitcnt vmcnt(18)
  s_waitcnt lgkmcnt(6)
  v_mfma_f32_32x32x16_bf16 v[8:23], v[72:75], v[120:123], v[8:23]
  ds_read_b64_tr_b16 v[88:89], v232 offset:8192
  ds_read_b64_tr_b16 v[90:91], v232 offset:8704
  v_mfma_f32_32x32x16_bf16 v[24:39], v[72:75], v[124:127], v[24:39]
  s_add_u32 s86, s84, 180224
  s_add_u32 m0, s85, 18432
  s_nop 0
  buffer_load_dwordx4 v240, s[52:55], s86 offen lds
  s_waitcnt lgkmcnt(6)
  v_mfma_f32_32x32x16_bf16 v[40:55], v[76:79], v[120:123], v[40:55]
  ds_read_b64_tr_b16 v[92:93], v233 offset:8192
  ds_read_b64_tr_b16 v[94:95], v233 offset:8704
  v_mfma_f32_32x32x16_bf16 v[56:71], v[76:79], v[124:127], v[56:71]
  s_add_u32 s86, s84, 188416
  s_add_u32 m0, s85, 19456
  s_nop 0
  buffer_load_dwordx4 v240, s[52:55], s86 offen lds
  s_add_u32 s66, s92, 24576
  s_addc_u32 s67, s93, 0
  global_load_dwordx4 v[104:107], v1, s[66:67] sc1
  global_load_dwordx4 v[108:111], v1, s[66:67] offset:512 sc1
  s_waitcnt vmcnt(18)
  s_waitcnt lgkmcnt(6)
  v_mfma_f32_32x32x16_bf16 v[8:23], v[80:83], v[128:131], v[8:23]
  ds_read_b64_tr_b16 v[96:97], v232 offset:10240
  ds_read_b64_tr_b16 v[98:99], v232 offset:10752
  v_mfma_f32_32x32x16_bf16 v[24:39], v[80:83], v[132:135], v[24:39]
  s_add_u32 s86, s84, 196608
  s_add_u32 m0, s85, 0
  s_nop 0
  buffer_load_dwordx4 v240, s[52:55], s86 offen lds
  s_waitcnt lgkmcnt(6)
  v_mfma_f32_32x32x16_bf16 v[40:55], v[84:87], v[128:131], v[40:55]
  ds_read_b64_tr_b16 v[100:101], v233 offset:10240
  ds_read_b64_tr_b16 v[102:103], v233 offset:10752
  v_mfma_f32_32x32x16_bf16 v[56:71], v[84:87], v[132:135], v[56:71]
  s_add_u32 s86, s84, 204800
  s_add_u32 m0, s85, 1024
  s_nop 0
  buffer_load_dwordx4 v240, s[52:55], s86 offen lds
  s_add_u32 s66, s92, 26624
  s_addc_u32 s67, s93, 0
  global_load_dwordx4 v[112:115], v1, s[66:67] sc1
  global_load_dwordx4 v[116:119], v1, s[66:67] offset:512 sc1
  s_waitcnt vmcnt(18)
  s_waitcnt lgkmcnt(6)
  v_mfma_f32_32x32x16_bf16 v[8:23], v[88:91], v[136:139], v[8:23]
  ds_read_b64_tr_b16 v[72:73], v232 offset:12288
  ds_read_b64_tr_b16 v[74:75], v232 offset:12800
  v_mfma_f32_32x32x16_bf16 v[24:39], v[88:91], v[140:143], v[24:39]
  s_add_u32 s86, s84, 212992
  s_add_u32 m0, s85, 2048
  s_nop 0
  buffer_load_dwordx4 v240, s[52:55], s86 offen lds
  s_waitcnt lgkmcnt(6)
  v_mfma_f32_32x32x16_bf16 v[40:55], v[92:95], v[136:139], v[40:55]
  ds_read_b64_tr_b16 v[76:77], v233 offset:12288
  ds_read_b64_tr_b16 v[78:79], v233 offset:12800
  v_mfma_f32_32x32x16_bf16 v[56:71], v[92:95], v[140:143], v[56:71]
  s_add_u32 s86, s84, 221184
  s_add_u32 m0, s85, 3072
  s_nop 0
  buffer_load_dwordx4 v240, s[52:55], s86 offen lds
  s_add_u32 s66, s92, 36864
  s_addc_u32 s67, s93, 0
  global_load_dwordx4 v[120:123], v1, s[66:67] sc1
  global_load_dwordx4 v[124:127], v1, s[66:67] offset:512 sc1
  s_waitcnt vmcnt(18)
  s_waitcnt lgkmcnt(6)
  v_mfma_f32_32x32x16_bf16 v[8:23], v[96:99], v[144:147], v[8:23]
  ds_read_b64_tr_b16 v[80:81], v232 offset:14336
  ds_read_b64_tr_b16 v[82:83], v232 offset:14848
  v_mfma_f32_32x32x16_bf16 v[24:39], v[96:99], v[148:151], v[24:39]
  s_add_u32 s86, s84, 294912
  s_add_u32 m0, s85, 4096
  s_nop 0
  buffer_load_dwordx4 v240, s[52:55], s86 offen lds
  s_waitcnt lgkmcnt(6)
  v_mfma_f32_32x32x16_bf16 v[40:55], v[100:103], v[144:147], v[40:55]
  ds_read_b64_tr_b16 v[84:85], v233 offset:14336
  ds_read_b64_tr_b16 v[86:87], v233 offset:14848
  v_mfma_f32_32x32x16_bf16 v[56:71], v[100:103], v[148:151], v[56:71]
  s_add_u32 s86, s84, 303104
  s_add_u32 m0, s85, 5120
  s_nop 0
  buffer_load_dwordx4 v240, s[52:55], s86 offen lds
  s_add_u32 s66, s92, 38912
  s_addc_u32 s67, s93, 0
  global_load_dwordx4 v[128:131], v1, s[66:67] sc1
  global_load_dwordx4 v[132:135], v1, s[66:67] offset:512 sc1
  s_waitcnt vmcnt(18)
  s_waitcnt lgkmcnt(6)
  v_mfma_f32_32x32x16_bf16 v[8:23], v[72:75], v[152:155], v[8:23]
  ds_read_b64_tr_b16 v[88:89], v232 offset:16384
  ds_read_b64_tr_b16 v[90:91], v232 offset:16896
  v_mfma_f32_32x32x16_bf16 v[24:39], v[72:75], v[156:159], v[24:39]
  s_add_u32 s86, s84, 311296
  s_add_u32 m0, s85, 6144
  s_nop 0
  buffer_load_dwordx4 v240, s[52:55], s86 offen lds
  s_waitcnt lgkmcnt(6)
  v_mfma_f32_32x32x16_bf16 v[40:55], v[76:79], v[152:155], v[40:55]
  ds_read_b64_tr_b16 v[92:93], v233 offset:16384
  ds_read_b64_tr_b16 v[94:95], v233 offset:16896
  v_mfma_f32_32x32x16_bf16 v[56:71], v[76:79], v[156:159], v[56:71]
  s_add_u32 s86, s84, 319488
  s_add_u32 m0, s85, 7168
  s_nop 0
  buffer_load_dwordx4 v240, s[52:55], s86 offen lds
  s_add_u32 s66, s92, 40960
  s_addc_u32 s67, s93, 0
  global_load_dwordx4 v[136:139], v1, s[66:67] sc1
  global_load_dwordx4 v[140:143], v1, s[66:67] offset:512 sc1
  s_waitcnt vmcnt(18)
  s_waitcnt lgkmcnt(6)
  v_mfma_f32_32x32x16_bf16 v[8:23], v[80:83], v[160:163], v[8:23]
  ds_read_b64_tr_b16 v[96:97], v232 offset:18432
  ds_read_b64_tr_b16 v[98:99], v232 offset:18944
  v_mfma_f32_32x32x16_bf16 v[24:39], v[80:83], v[164:167], v[24:39]
  s_add_u32 s86, s84, 327680
  s_add_u32 m0, s85, 8192
  s_nop 0
  buffer_load_dwordx4 v240, s[52:55], s86 offen lds
  s_waitcnt lgkmcnt(6)
  v_mfma_f32_32x32x16_bf16 v[40:55], v[84:87], v[160:163], v[40:55]
  ds_read_b64_tr_b16 v[100:101], v233 offset:18432
  ds_read_b64_tr_b16 v[102:103], v233 offset:18944
  v_mfma_f32_32x32x16_bf16 v[56:71], v[84:87], v[164:167], v[56:71]
  s_add_u32 s86, s84, 335872
  s_add_u32 m0, s85, 9216
  s_nop 0
  buffer_load_dwordx4 v240, s[52:55], s86 offen lds
  s_add_u32 s66, s92, 51200
  s_addc_u32 s67, s93, 0
  global_load_dwordx4 v[144:147], v1, s[66:67] sc1
  global_load_dwordx4 v[148:151], v1, s[66:67] offset:512 sc1
  s_waitcnt vmcnt(18)
  s_waitcnt lgkmcnt(6)
  v_mfma_f32_32x32x16_bf16 v[8:23], v[88:91], v[168:171], v[8:23]
  ds_read_b64_tr_b16 v[72:73], v232 offset:0
  ds_read_b64_tr_b16 v[74:75], v232 offset:512
  v_mfma_f32_32x32x16_bf16 v[24:39], v[88:91], v[172:175], v[24:39]
  s_add_u32 s86, s84, 409600
  s_add_u32 m0, s85, 10240
  s_nop 0
  buffer_load_dwordx4 v240, s[52:55], s86 offen lds
  s_waitcnt lgkmcnt(6)
  v_mfma_f32_32x32x16_bf16 v[40:55], v[92:95], v[168:171], v[40:55]
  ds_read_b64_tr_b16 v[76:77], v233 offset:0
  ds_read_b64_tr_b16 v[78:79], v233 offset:512
  v_mfma_f32_32x32x16_bf16 v[56:71], v[92:95], v[172:175], v[56:71]
  s_add_u32 s86, s84, 417792
  s_add_u32 m0, s85, 11264
  s_nop 0
  buffer_load_dwordx4 v240, s[52:55], s86 offen lds
  s_add_u32 s66, s92, 53248
  s_addc_u32 s67, s93, 0
  global_load_dwordx4 v[152:155], v1, s[66:67] sc1
  global_load_dwordx4 v[156:159], v1, s[66:67] offset:512 sc1
  s_waitcnt vmcnt(18)
  s_waitcnt lgkmcnt(6)
  v_mfma_f32_32x32x16_bf16 v[8:23], v[96:99], v[176:179], v[8:23]
  ds_read_b64_tr_b16 v[80:81], v232 offset:2048
  ds_read_b64_tr_b16 v[82:83], v232 offset:2560
  v_mfma_f32_32x32x16_bf16 v[24:39], v[96:99], v[180:183], v[24:39]
  s_add_u32 s86, s84, 425984
  s_add_u32 m0, s85, 12288
  s_nop 0
  buffer_load_dwordx4 v240, s[52:55], s86 offen lds
  s_waitcnt lgkmcnt(6)
  v_mfma_f32_32x32x16_bf16 v[40:55], v[100:103], v[176:179], v[40:55]
  ds_read_b64_tr_b16 v[84:85], v233 offset:2048
  ds_read_b64_tr_b16 v[86:87], v233 offset:2560
  v_mfma_f32_32x32x16_bf16 v[56:71], v[100:103], v[180:183], v[56:71]
  s_add_u32 s86, s84, 434176
  s_add_u32 m0, s85, 13312
  s_nop 0
  buffer_load_dwordx4 v240, s[52:55], s86 offen lds
  s_add_u32 s66, s92, 55296
  s_addc_u32 s67, s93, 0
  global_load_dwordx4 v[160:163], v1, s[66:67] sc1
  global_load_dwordx4 v[164:167], v1, s[66:67] offset:512 sc1
  s_waitcnt vmcnt(18)
  s_waitcnt lgkmcnt(6)
  v_mfma_f32_32x32x16_bf16 v[8:23], v[72:75], v[104:107], v[8:23]
  ds_read_b64_tr_b16 v[88:89], v232 offset:4096
  ds_read_b64_tr_b16 v[90:91], v232 offset:4608
  v_mfma_f32_32x32x16_bf16 v[24:39], v[72:75], v[108:111], v[24:39]
  s_add_u32 s86, s84, 442368
  s_add_u32 m0, s85, 14336
  s_nop 0
  buffer_load_dwordx4 v240, s[52:55], s86 offen lds
  s_waitcnt lgkmcnt(6)
  v_mfma_f32_32x32x16_bf16 v[40:55], v[76:79], v[104:107], v[40:55]
  ds_read_b64_tr_b16 v[92:93], v233 offset:4096
  ds_read_b64_tr_b16 v[94:95], v233 offset:4608
  v_mfma_f32_32x32x16_bf16 v[56:71], v[76:79], v[108:111], v[56:71]
  s_add_u32 s86, s84, 450560
  s_add_u32 m0, s85, 15360
  s_nop 0
  buffer_load_dwordx4 v240, s[52:55], s86 offen lds
  s_waitcnt vmcnt(16)
  s_waitcnt lgkmcnt(6)
  v_mfma_f32_32x32x16_bf16 v[8:23], v[80:83], v[112:115], v[8:23]
  ds_read_b64_tr_b16 v[96:97], v232 offset:6144
  ds_read_b64_tr_b16 v[98:99], v232 offset:6656
  v_mfma_f32_32x32x16_bf16 v[24:39], v[80:83], v[116:119], v[24:39]
  s_waitcnt lgkmcnt(6)
  v_mfma_f32_32x32x16_bf16 v[40:55], v[84:87], v[112:115], v[40:55]
  ds_read_b64_tr_b16 v[100:101], v233 offset:6144
  ds_read_b64_tr_b16 v[102:103], v233 offset:6656
  v_mfma_f32_32x32x16_bf16 v[56:71], v[84:87], v[116:119], v[56:71]
  s_cmp_lg_u32 s50, 0
  s_cbranch_scc1 Lpl_17
  v_and_b32 v244, 31, v0
  v_lshlrev_b32 v244, 3, v244
  s_mul_i32 s6, s81, 256
  s_add_u32 s6, s6, 12587008
  v_add_u32 v244, s6, v244
  s_mov_b32 s6, 0
Lplp_18:
  global_load_dwordx2 v[246:247], v244, s[46:47] offset:0 sc1
  s_waitcnt vmcnt(0)
  v_xor_b32 v246, s8, v246
  v_xor_b32 v247, s9, v247
  v_or_b32 v246, v246, v247
  v_cmp_ne_u32 vcc, 0, v246
  s_add_u32 s6, s6, 1
  s_cmp_gt_u32 s6, 200000
  s_cbranch_scc1 Lpld_19
  s_cbranch_vccz Lpld_19
  s_sleep 4
  s_branch Lplp_18
Lpld_19:
Lpl_17:
  s_barrier
  s_add_u32 s64, s46, 9437184
  s_addc_u32 s65, s47, 0
  v_add_u32 v208, 0, v237
  global_load_ushort v192, v208, s[64:65] sc1
  v_add_u32 v209, 4096, v237
  global_load_ushort v193, v209, s[64:65] sc1
  v_add_u32 v210, 8192, v237
  global_load_ushort v194, v210, s[64:65] sc1
  v_add_u32 v211, 12288, v237
  global_load_ushort v195, v211, s[64:65] sc1
  v_add_u32 v212, 32768, v237
  global_load_ushort v196, v212, s[64:65] sc1
  v_add_u32 v213, 36864, v237
  global_load_ushort v197, v213, s[64:65] sc1
  v_add_u32 v214, 40960, v237
  global_load_ushort v198, v214, s[64:65] sc1
  v_add_u32 v215, 45056, v237
  global_load_ushort v199, v215, s[64:65] sc1
  v_add_u32 v216, 65536, v237
  global_load_ushort v200, v216, s[64:65] sc1
  v_add_u32 v217, 69632, v237
  global_load_ushort v201, v217, s[64:65] sc1
  v_add_u32 v218, 73728, v237
  global_load_ushort v202, v218, s[64:65] sc1
  v_add_u32 v219, 77824, v237
  global_load_ushort v203, v219, s[64:65] sc1
  v_add_u32 v220, 98304, v237
  global_load_ushort v204, v220, s[64:65] sc1
  v_add_u32 v221, 102400, v237
  global_load_ushort v205, v221, s[64:65] sc1
  v_add_u32 v222, 106496, v237
  global_load_ushort v206, v222, s[64:65] sc1
  v_add_u32 v223, 110592, v237
  global_load_ushort v207, v223, s[64:65] sc1
  s_waitcnt vmcnt(28)
  s_waitcnt lgkmcnt(6)
  v_mfma_f32_32x32x16_bf16 v[8:23], v[88:91], v[120:123], v[8:23]
  ds_read_b64_tr_b16 v[72:73], v232 offset:8192
  ds_read_b64_tr_b16 v[74:75], v232 offset:8704
  v_mfma_f32_32x32x16_bf16 v[24:39], v[88:91], v[124:127], v[24:39]
  s_waitcnt lgkmcnt(6)
  v_mfma_f32_32x32x16_bf16 v[40:55], v[92:95], v[120:123], v[40:55]
  ds_read_b64_tr_b16 v[76:77], v233 offset:8192
  ds_read_b64_tr_b16 v[78:79], v233 offset:8704
  v_mfma_f32_32x32x16_bf16 v[56:71], v[92:95], v[124:127], v[56:71]
  s_waitcnt vmcnt(24)
  s_waitcnt lgkmcnt(6)
  v_mfma_f32_32x32x16_bf16 v[8:23], v[96:99], v[128:131], v[8:23]
  ds_read_b64_tr_b16 v[80:81], v232 offset:10240
  ds_read_b64_tr_b16 v[82:83], v232 offset:10752
  v_mfma_f32_32x32x16_bf16 v[24:39], v[96:99], v[132:135], v[24:39]
  s_waitcnt lgkmcnt(6)
  v_mfma_f32_32x32x16_bf16 v[40:55], v[100:103], v[128:131], v[40:55]
  ds_read_b64_tr_b16 v[84:85], v233 offset:10240
  ds_read_b64_tr_b16 v[86:87], v233 offset:10752
  v_mfma_f32_32x32x16_bf16 v[56:71], v[100:103], v[132:135], v[56:71]
  s_waitcnt vmcnt(20)
  s_waitcnt lgkmcnt(6)
  v_mfma_f32_32x32x16_bf16 v[8:23], v[72:75], v[136:139], v[8:23]
  ds_read_b64_tr_b16 v[88:89], v232 offset:12288
  ds_read_b64_tr_b16 v[90:91], v232 offset:12800
  v_mfma_f32_32x32x16_bf16 v[24:39], v[72:75], v[140:143], v[24:39]
  s_waitcnt lgkmcnt(6)
  v_mfma_f32_32x32x16_bf16 v[40:55], v[76:79], v[136:139], v[40:55]
  ds_read_b64_tr_b16 v[92:93], v233 offset:12288
  ds_read_b64_tr_b16 v[94:95], v233 offset:12800
  v_mfma_f32_32x32x16_bf16 v[56:71], v[76:79], v[140:143], v[56:71]
  s_waitcnt vmcnt(16)
  s_waitcnt lgkmcnt(6)
  v_mfma_f32_32x32x16_bf16 v[8:23], v[80:83], v[144:147], v[8:23]
  ds_read_b64_tr_b16 v[96:97], v232 offset:14336
  ds_read_b64_tr_b16 v[98:99], v232 offset:14848
  v_mfma_f32_32x32x16_bf16 v[24:39], v[80:83], v[148:151], v[24:39]
  s_waitcnt lgkmcnt(6)
  v_mfma_f32_32x32x16_bf16 v[40:55], v[84:87], v[144:147], v[40:55]
  ds_read_b64_tr_b16 v[100:101], v233 offset:14336
  ds_read_b64_tr_b16 v[102:103], v233 offset:14848
  v_mfma_f32_32x32x16_bf16 v[56:71], v[84:87], v[148:151], v[56:71]
  s_waitcnt vmcnt(22)
  s_waitcnt lgkmcnt(6)
  v_mfma_f32_32x32x16_bf16 v[8:23], v[88:91], v[152:155], v[8:23]
  v_mfma_f32_32x32x16_bf16 v[24:39], v[88:91], v[156:159], v[24:39]
  s_waitcnt lgkmcnt(4)
  v_mfma_f32_32x32x16_bf16 v[40:55], v[92:95], v[152:155], v[40:55]
  v_mfma_f32_32x32x16_bf16 v[56:71], v[92:95], v[156:159], v[56:71]
  s_waitcnt vmcnt(18)
  s_waitcnt lgkmcnt(2)
  v_mfma_f32_32x32x16_bf16 v[8:23], v[96:99], v[160:163], v[8:23]
  v_mfma_f32_32x32x16_bf16 v[24:39], v[96:99], v[164:167], v[24:39]
  s_waitcnt lgkmcnt(0)
  v_mfma_f32_32x32x16_bf16 v[40:55], v[100:103], v[160:163], v[40:55]
  v_mfma_f32_32x32x16_bf16 v[56:71], v[100:103], v[164:167], v[56:71]
  s_barrier
  s_nop 7
  s_lshl_b32 s88, s50, 14
  v_lshlrev_b32 v1, 4, v0
  v_add_u32 v2, s88, v1
  ds_write_b128 v2, v[8:11] offset:0
  ds_write_b128 v2, v[12:15] offset:1024
  ds_write_b128 v2, v[16:19] offset:2048
  ds_write_b128 v2, v[20:23] offset:3072
  ds_write_b128 v2, v[24:27] offset:4096
  ds_write_b128 v2, v[28:31] offset:5120
  ds_write_b128 v2, v[32:35] offset:6144
  ds_write_b128 v2, v[36:39] offset:7168
  ds_write_b128 v2, v[40:43] offset:8192
  ds_write_b128 v2, v[44:47] offset:9216
  ds_write_b128 v2, v[48:51] offset:10240
  ds_write_b128 v2, v[52:55] offset:11264
  ds_write_b128 v2, v[56:59] offset:12288
  ds_write_b128 v2, v[60:63] offset:13312
  ds_write_b128 v2, v[64:67] offset:14336
  ds_write_b128 v2, v[68:71] offset:15360
  s_waitcnt lgkmcnt(0)
  s_barrier
  s_lshl_b32 s88, s50, 12
  v_lshlrev_b32 v1, 4, v0
  v_add_u32 v2, s88, v1
  ds_read_b128 v[72:75], v2 offset:0
  ds_read_b128 v[76:79], v2 offset:1024
  ds_read_b128 v[80:83], v2 offset:2048
  ds_read_b128 v[84:87], v2 offset:3072
  ds_read_b128 v[88:91], v2 offset:16384
  ds_read_b128 v[92:95], v2 offset:17408
  ds_read_b128 v[96:99], v2 offset:18432
  ds_read_b128 v[100:103], v2 offset:19456
  ds_read_b128 v[104:107], v2 offset:32768
  ds_read_b128 v[108:111], v2 offset:33792
  ds_read_b128 v[112:115], v2 offset:34816
  ds_read_b128 v[116:119], v2 offset:35840
  ds_read_b128 v[120:123], v2 offset:49152
  ds_read_b128 v[124:127], v2 offset:50176
  ds_read_b128 v[128:131], v2 offset:51200
  ds_read_b128 v[132:135], v2 offset:52224
  s_waitcnt lgkmcnt(0)
  v_add_f32 v72, v72, v88
  v_add_f32 v104, v104, v120
  v_add_f32 v72, v72, v104
  v_add_f32 v73, v73, v89
  v_add_f32 v105, v105, v121
  v_add_f32 v73, v73, v105
  v_add_f32 v74, v74, v90
  v_add_f32 v106, v106, v122
  v_add_f32 v74, v74, v106
  v_add_f32 v75, v75, v91
  v_add_f32 v107, v107, v123
  v_add_f32 v75, v75, v107
  v_add_f32 v76, v76, v92
  v_add_f32 v108, v108, v124
  v_add_f32 v76, v76, v108
  v_add_f32 v77, v77, v93
  v_add_f32 v109, v109, v125
  v_add_f32 v77, v77, v109
  v_add_f32 v78, v78, v94
  v_add_f32 v110, v110, v126
  v_add_f32 v78, v78, v110
  v_add_f32 v79, v79, v95
  v_add_f32 v111, v111, v127
  v_add_f32 v79, v79, v111
  v_add_f32 v80, v80, v96
  v_add_f32 v112, v112, v128
  v_add_f32 v80, v80, v112
  v_add_f32 v81, v81, v97
  v_add_f32 v113, v113, v129
  v_add_f32 v81, v81, v113
  v_add_f32 v82, v82, v98
  v_add_f32 v114, v114, v130
  v_add_f32 v82, v82, v114
  v_add_f32 v83, v83, v99
  v_add_f32 v115, v115, v131
  v_add_f32 v83, v83, v115
  v_add_f32 v84, v84, v100
  v_add_f32 v116, v116, v132
  v_add_f32 v84, v84, v116
  v_add_f32 v85, v85, v101
  v_add_f32 v117, v117, v133
  v_add_f32 v85, v85, v117
  v_add_f32 v86, v86, v102
  v_add_f32 v118, v118, v134
  v_add_f32 v86, v86, v118
  v_add_f32 v87, v87, v103
  v_add_f32 v119, v119, v135
  v_add_f32 v87, v87, v119
  s_mov_b32 s69, 0xbfb8aa3b
  v_cvt_pk_bf16_f32 v104, v72, v73
  v_cvt_pk_bf16_f32 v105, v74, v75
  v_cvt_pk_bf16_f32 v106, v76, v77
  v_cvt_pk_bf16_f32 v107, v78, v79
  v_cvt_pk_bf16_f32 v108, v80, v81
  v_cvt_pk_bf16_f32 v109, v82, v83
  v_cvt_pk_bf16_f32 v110, v84, v85
  v_cvt_pk_bf16_f32 v111, v86, v87
  v_lshlrev_b32 v72, 16, v104
  v_lshlrev_b32 v74, 16, v105
  v_lshlrev_b32 v76, 16, v106
  v_lshlrev_b32 v78, 16, v107
  v_lshlrev_b32 v80, 16, v108
  v_lshlrev_b32 v82, 16, v109
  v_lshlrev_b32 v84, 16, v110
  v_lshlrev_b32 v86, 16, v111
  v_and_b32 v73, 0xffff0000, v104
  v_and_b32 v75, 0xffff0000, v105
  v_and_b32 v77, 0xffff0000, v106
  v_and_b32 v79, 0xffff0000, v107
  v_and_b32 v81, 0xffff0000, v108
  v_and_b32 v83, 0xffff0000, v109
  v_and_b32 v85, 0xffff0000, v110
  v_and_b32 v87, 0xffff0000, v111
  v_mul_f32 v88, s69, v72
  v_mul_f32 v90, s69, v74
  v_mul_f32 v92, s69, v76
  v_mul_f32 v94, s69, v78
  v_mul_f32 v96, s69, v80
  v_mul_f32 v98, s69, v82
  v_mul_f32 v100, s69, v84
  v_mul_f32 v102, s69, v86
  v_mul_f32 v89, s69, v73
  v_mul_f32 v91, s69, v75
  v_mul_f32 v93, s69, v77
  v_mul_f32 v95, s69, v79
  v_mul_f32 v97, s69, v81
  v_mul_f32 v99, s69, v83
  v_mul_f32 v101, s69, v85
  v_mul_f32 v103, s69, v87
  v_exp_f32 v88, v88
  v_exp_f32 v90, v90
  v_exp_f32 v92, v92
  v_exp_f32 v94, v94
  v_exp_f32 v96, v96
  v_exp_f32 v98, v98
  v_exp_f32 v100, v100
  v_exp_f32 v102, v102
  v_exp_f32 v89, v89
  v_exp_f32 v91, v91
  v_exp_f32 v93, v93
  v_exp_f32 v95, v95
  v_exp_f32 v97, v97
  v_exp_f32 v99, v99
  v_exp_f32 v101, v101
  v_exp_f32 v103, v103
  v_add_f32 v88, 1.0, v88
  v_add_f32 v90, 1.0, v90
  v_add_f32 v92, 1.0, v92
  v_add_f32 v94, 1.0, v94
  v_add_f32 v96, 1.0, v96
  v_add_f32 v98, 1.0, v98
  v_add_f32 v100, 1.0, v100
  v_add_f32 v102, 1.0, v102
  v_add_f32 v89, 1.0, v89
  v_add_f32 v91, 1.0, v91
  v_add_f32 v93, 1.0, v93
  v_add_f32 v95, 1.0, v95
  v_add_f32 v97, 1.0, v97
  v_add_f32 v99, 1.0, v99
  v_add_f32 v101, 1.0, v101
  v_add_f32 v103, 1.0, v103
  v_rcp_f32 v88, v88
  v_rcp_f32 v90, v90
  v_rcp_f32 v92, v92
  v_rcp_f32 v94, v94
  v_rcp_f32 v96, v96
  v_rcp_f32 v98, v98
  v_rcp_f32 v100, v100
  v_rcp_f32 v102, v102
  v_rcp_f32 v89, v89
  v_rcp_f32 v91, v91
  v_rcp_f32 v93, v93
  v_rcp_f32 v95, v95
  v_rcp_f32 v97, v97
  v_rcp_f32 v99, v99
  v_rcp_f32 v101, v101
  v_rcp_f32 v103, v103
  v_mul_f32 v72, v72, v88
  v_mul_f32 v74, v74, v90
  v_mul_f32 v76, v76, v92
  v_mul_f32 v78, v78, v94
  v_mul_f32 v80, v80, v96
  v_mul_f32 v82, v82, v98
  v_mul_f32 v84, v84, v100
  v_mul_f32 v86, v86, v102
  v_mul_f32 v73, v73, v89
  v_mul_f32 v75, v75, v91
  v_mul_f32 v77, v77, v93
  v_mul_f32 v79, v79, v95
  v_mul_f32 v81, v81, v97
  v_mul_f32 v83, v83, v99
  v_mul_f32 v85, v85, v101
  v_mul_f32 v87, v87, v103
  v_cvt_pk_bf16_f32 v104, v72, v73
  v_cvt_pk_bf16_f32 v105, v74, v75
  v_cvt_pk_bf16_f32 v106, v76, v77
  v_cvt_pk_bf16_f32 v107, v78, v79
  v_cvt_pk_bf16_f32 v108, v80, v81
  v_cvt_pk_bf16_f32 v109, v82, v83
  v_cvt_pk_bf16_f32 v110, v84, v85
  v_cvt_pk_bf16_f32 v111, v86, v87
  v_lshlrev_b32 v72, 16, v104
  v_lshlrev_b32 v74, 16, v105
  v_lshlrev_b32 v76, 16, v106
  v_lshlrev_b32 v78, 16, v107
  v_lshlrev_b32 v80, 16, v108
  v_lshlrev_b32 v82, 16, v109
  v_lshlrev_b32 v84, 16, v110
  v_lshlrev_b32 v86, 16, v111
  v_and_b32 v73, 0xffff0000, v104
  v_and_b32 v75, 0xffff0000, v105
  v_and_b32 v77, 0xffff0000, v106
  v_and_b32 v79, 0xffff0000, v107
  v_and_b32 v81, 0xffff0000, v108
  v_and_b32 v83, 0xffff0000, v109
  v_and_b32 v85, 0xffff0000, v110
  v_and_b32 v87, 0xffff0000, v111
  s_waitcnt vmcnt(0)
  v_lshlrev_b32 v192, 16, v192
  v_lshlrev_b32 v194, 16, v194
  v_lshlrev_b32 v196, 16, v196
  v_lshlrev_b32 v198, 16, v198
  v_lshlrev_b32 v200, 16, v200
  v_lshlrev_b32 v202, 16, v202
  v_lshlrev_b32 v204, 16, v204
  v_lshlrev_b32 v206, 16, v206
  v_lshlrev_b32 v193, 16, v193
  v_lshlrev_b32 v195, 16, v195
  v_lshlrev_b32 v197, 16, v197
  v_lshlrev_b32 v199, 16, v199
  v_lshlrev_b32 v201, 16, v201
  v_lshlrev_b32 v203, 16, v203
  v_lshlrev_b32 v205, 16, v205
  v_lshlrev_b32 v207, 16, v207
  v_mul_f32 v72, v72, v192
  v_mul_f32 v74, v74, v194
  v_mul_f32 v76, v76, v196
  v_mul_f32 v78, v78, v198
  v_mul_f32 v80, v80, v200
  v_mul_f32 v82, v82, v202
  v_mul_f32 v84, v84, v204
  v_mul_f32 v86, v86, v206
  v_mul_f32 v73, v73, v193
  v_mul_f32 v75, v75, v195
  v_mul_f32 v77, v77, v197
  v_mul_f32 v79, v79, v199
  v_mul_f32 v81, v81, v201
  v_mul_f32 v83, v83, v203
  v_mul_f32 v85, v85, v205
  v_mul_f32 v87, v87, v207
  v_cvt_pk_bf16_f32 v104, v72, v73
  v_cvt_pk_bf16_f32 v105, v74, v75
  v_cvt_pk_bf16_f32 v106, v76, v77
  v_cvt_pk_bf16_f32 v107, v78, v79
  v_cvt_pk_bf16_f32 v108, v80, v81
  v_cvt_pk_bf16_f32 v109, v82, v83
  v_cvt_pk_bf16_f32 v110, v84, v85
  v_cvt_pk_bf16_f32 v111, v86, v87
  v_lshlrev_b32 v72, 16, v104
  v_lshlrev_b32 v74, 16, v105
  v_lshlrev_b32 v76, 16, v106
  v_lshlrev_b32 v78, 16, v107
  v_lshlrev_b32 v80, 16, v108
  v_lshlrev_b32 v82, 16, v109
  v_lshlrev_b32 v84, 16, v110
  v_lshlrev_b32 v86, 16, v111
  v_and_b32 v73, 0xffff0000, v104
  v_and_b32 v75, 0xffff0000, v105
  v_and_b32 v77, 0xffff0000, v106
  v_and_b32 v79, 0xffff0000, v107
  v_and_b32 v81, 0xffff0000, v108
  v_and_b32 v83, 0xffff0000, v109
  v_and_b32 v85, 0xffff0000, v110
  v_and_b32 v87, 0xffff0000, v111
  v_lshlrev_b32 v88, 16, v184
  v_lshlrev_b32 v90, 16, v185
  v_lshlrev_b32 v92, 16, v186
  v_lshlrev_b32 v94, 16, v187
  v_lshlrev_b32 v96, 16, v188
  v_lshlrev_b32 v98, 16, v189
  v_lshlrev_b32 v100, 16, v190
  v_lshlrev_b32 v102, 16, v191
  v_and_b32 v89, 0xffff0000, v184
  v_and_b32 v91, 0xffff0000, v185
  v_and_b32 v93, 0xffff0000, v186
  v_and_b32 v95, 0xffff0000, v187
  v_and_b32 v97, 0xffff0000, v188
  v_and_b32 v99, 0xffff0000, v189
  v_and_b32 v101, 0xffff0000, v190
  v_and_b32 v103, 0xffff0000, v191
  v_add_f32 v72, v72, v88
  v_add_f32 v74, v74, v90
  v_add_f32 v76, v76, v92
  v_add_f32 v78, v78, v94
  v_add_f32 v80, v80, v96
  v_add_f32 v82, v82, v98
  v_add_f32 v84, v84, v100
  v_add_f32 v86, v86, v102
  v_add_f32 v73, v73, v89
  v_add_f32 v75, v75, v91
  v_add_f32 v77, v77, v93
  v_add_f32 v79, v79, v95
  v_add_f32 v81, v81, v97
  v_add_f32 v83, v83, v99
  v_add_f32 v85, v85, v101
  v_add_f32 v87, v87, v103
  v_cvt_pk_bf16_f32 v112, v72, v73
  v_cvt_pk_bf16_f32 v113, v74, v75
  v_cvt_pk_bf16_f32 v114, v76, v77
  v_cvt_pk_bf16_f32 v115, v78, v79
  v_cvt_pk_bf16_f32 v116, v80, v81
  v_cvt_pk_bf16_f32 v117, v82, v83
  v_cvt_pk_bf16_f32 v118, v84, v85
  v_cvt_pk_bf16_f32 v119, v86, v87
  global_store_dwordx2 v236, v[112:113], s[42:43] offset:0
  global_store_dwordx2 v236, v[114:115], s[42:43] offset:16
  global_store_dwordx2 v236, v[116:117], s[42:43] offset:32
  global_store_dwordx2 v236, v[118:119], s[42:43] offset:48
  s_waitcnt vmcnt(0)
  s_branch Lend
LprogX:
  s_setprio 2
  s_mov_b32 s71, s50
  s_lshl_b32 s72, s4, 6
  s_lshl_b32 s73, s5, 1
  s_add_u32 s72, s72, s73
  v_and_b32 v1, 31, v0
  s_lshl_b32 s73, s72, 7
  s_lshl_b32 s74, s71, 5
  s_add_u32 s73, s73, s74
  v_add_u32 v1, s73, v1
  v_lshlrev_b32 v1, 1, v1
  s_lshl_b32 s73, s72, 1
  v_mov_b32 v2, s73
  global_load_ushort v224, v1, s[18:19] offset:0
  global_load_ushort v225, v1, s[20:21] offset:0
  global_load_ushort v226, v1, s[22:23] offset:0
  global_load_ushort v227, v1, s[24:25] offset:0
  global_load_ushort v228, v1, s[26:27] offset:0
  global_load_ushort v229, v1, s[28:29] offset:0
  global_load_ushort v230, v2, s[30:31] offset:0
  global_load_ushort v231, v2, s[32:33] offset:0
  global_load_ushort v232, v1, s[18:19] offset:256
  global_load_ushort v233, v1, s[20:21] offset:256
  global_load_ushort v234, v1, s[22:23] offset:256
  global_load_ushort v235, v1, s[24:25] offset:256
  global_load_ushort v236, v1, s[26:27] offset:256
  global_load_ushort v237, v1, s[28:29] offset:256
  global_load_ushort v238, v2, s[30:31] offset:2
  global_load_ushort v239, v2, s[32:33] offset:2
  v_min_u32 v4, 55, v0
  v_lshlrev_b32 v4, 7, v4
  s_mul_i32 s6, s3, 7168
  v_add_u32 v4, s6, v4
  s_cmp_eq_u32 s50, 0
  s_cselect_b32 s6, s36, s38
  s_cselect_b32 s7, s37, s39
  s_cmp_eq_u32 s50, 2
  s_cselect_b32 s6, s40, s6
  s_cselect_b32 s7, s41, s7
  global_load_dword v243, v4, s[6:7]
  s_waitcnt vmcnt(9)
  v_lshlrev_b32 v224, 16, v224
  v_lshlrev_b32 v225, 16, v225
  v_lshlrev_b32 v226, 16, v226
  v_lshlrev_b32 v227, 16, v227
  v_lshlrev_b32 v228, 16, v228
  v_lshlrev_b32 v229, 16, v229
  v_lshlrev_b32 v230, 16, v230
  v_lshlrev_b32 v231, 16, v231
  s_mov_b32 s74, 0x3fb8aa3b
  s_mov_b32 s75, 0x32a57060
  v_mul_f32 v15, s74, v230
  v_fma_f32 v16, v230, s74, -v15
  v_fma_f32 v16, v230, s75, v16
  v_exp_f32 v15, v15
  v_mul_f32 v16, 0x3f317218, v16
  v_fma_f32 v15, v15, v16, v15
  v_cvt_pk_bf16_f32 v15, v15, v15
  v_lshlrev_b32 v15, 16, v15
  v_mul_f32 v8, v15, v224
  v_mul_f32 v9, v15, v225
  v_mul_f32 v10, v15, v226
  v_mul_f32 v11, v15, v227
  v_pk_mul_f32 v[18:19], v[228:229], v[10:11] op_sel_hi:[1,0]
  v_pk_fma_f32 v[18:19], v[228:229], v[10:11], v[18:19] op_sel:[1,1,0] op_sel_hi:[0,1,1] neg_lo:[1,0,0]
  v_mul_f32 v16, s74, v8
  v_mul_f32 v17, 0x3e22f983, v9
  v_mul_f32 v30, 0x41800000, v16
  v_mul_f32 v32, 0x44000000, v16
  v_mul_f32 v34, 0x45000000, v16
  v_mul_f32 v31, 0x41800000, v17
  v_mul_f32 v33, 0x44000000, v17
  v_mul_f32 v35, 0x45000000, v17
  v_exp_f32 v30, v30
  v_exp_f32 v32, v32
  v_exp_f32 v34, v34
  v_fract_f32 v31, v31
  v_fract_f32 v33, v33
  v_fract_f32 v35, v35
  v_cos_f32 v20, v31
  v_cos_f32 v22, v33
  v_cos_f32 v24, v35
  v_sin_f32 v21, v31
  v_sin_f32 v23, v33
  v_sin_f32 v25, v35
  s_nop 0
  s_nop 0
  s_nop 0
  v_mul_f32 v20, v20, v30
  v_mul_f32 v22, v22, v32
  v_mul_f32 v24, v24, v34
  v_mul_f32 v21, v21, v30
  v_mul_f32 v23, v23, v32
  v_mul_f32 v25, v25, v34
  v_mul_f32 v26, v19, v25
  v_fma_f32 v26, v18, v24, -v26
  v_mul_f32 v27, 0x45000000, v16
  v_max_f32 v27, 0, v27
  v_exp_f32 v27, v27
  v_add_f32 v28, abs(v18), abs(v19)
  v_mul_f32 v27, v27, v28
  v_cmp_gt_u32 vcc, 32, v0
  s_nop 1
  v_cndmask_b32 v26, 0, v26, vcc
  v_cndmask_b32 v27, 0, v27, vcc
  s_nop 1
  v_add_f32_dpp v26, v26, v26 row_shr:1 row_mask:0xf bank_mask:0xf bound_ctrl:0
  s_nop 1
  v_add_f32_dpp v26, v26, v26 row_shr:2 row_mask:0xf bank_mask:0xf bound_ctrl:0
  s_nop 1
  v_add_f32_dpp v26, v26, v26 row_shr:4 row_mask:0xf bank_mask:0xf bound_ctrl:0
  s_nop 1
  v_add_f32_dpp v26, v26, v26 row_shr:8 row_mask:0xf bank_mask:0xf bound_ctrl:0
  s_nop 1
  v_add_f32_dpp v26, v26, v26 row_bcast:15 row_mask:0xa bank_mask:0xf
  s_nop 1
  v_add_f32_dpp v26, v26, v26 row_bcast:31 row_mask:0xc bank_mask:0xf
  s_nop 1
  s_nop 1
  v_add_f32_dpp v27, v27, v27 row_shr:1 row_mask:0xf bank_mask:0xf bound_ctrl:0
  s_nop 1
  v_add_f32_dpp v27, v27, v27 row_shr:2 row_mask:0xf bank_mask:0xf bound_ctrl:0
  s_nop 1
  v_add_f32_dpp v27, v27, v27 row_shr:4 row_mask:0xf bank_mask:0xf bound_ctrl:0
  s_nop 1
  v_add_f32_dpp v27, v27, v27 row_shr:8 row_mask:0xf bank_mask:0xf bound_ctrl:0
  s_nop 1
  v_add_f32_dpp v27, v27, v27 row_bcast:15 row_mask:0xa bank_mask:0xf
  s_nop 1
  v_add_f32_dpp v27, v27, v27 row_bcast:31 row_mask:0xc bank_mask:0xf
  s_nop 1
  s_mul_i32 s78, s50, 9360
  s_add_u32 s78, s78, 0
  v_and_b32 v1, 31, v0
  v_lshlrev_b32 v1, 5, v1
  v_add_u32 v1, s78, v1
  ds_write_b128 v1, v[16:19]
  ds_write_b128 v1, v[20:23] offset:16
  v_readlane_b32 s76, v26, 63
  v_readlane_b32 s77, v27, 63
  s_nop 1
  v_mov_b32 v2, s76
  v_mov_b32 v3, s77
  v_mov_b32 v1, s78
  ds_write_b64 v1, v[2:3] offset:9216
  v_mov_b32 v192, 0
  v_mov_b32 v193, 0
  v_mov_b32 v194, 0
  v_mov_b32 v195, 0
  v_mov_b32 v196, 0
  v_mov_b32 v197, 0
  v_mov_b32 v198, 0
  v_mov_b32 v199, 0
  v_mov_b32 v200, 0
  v_mov_b32 v201, 0
  v_mov_b32 v202, 0
  v_mov_b32 v203, 0
  v_mov_b32 v204, 0
  v_mov_b32 v205, 0
  v_mov_b32 v206, 0
  v_mov_b32 v207, 0
  v_mov_b32 v208, 0
  v_mov_b32 v209, 0
  v_mov_b32 v210, 0
  v_mov_b32 v211, 0
  v_mov_b32 v212, 0
  v_mov_b32 v213, 0
  v_mov_b32 v214, 0
  v_mov_b32 v215, 0
  v_mov_b32 v216, 0
  v_mov_b32 v217, 0
  v_mov_b32 v218, 0
  v_mov_b32 v219, 0
  v_mov_b32 v220, 0
  v_mov_b32 v221, 0
  v_mov_b32 v222, 0
  v_mov_b32 v223, 0
  v_and_b32 v1, 15, v0
  v_cvt_f32_u32 v2, v1
  v_mul_f32 v4, 0x42000000, v2
  v_mov_b32 v3, v2
  v_mov_b32 v5, v4
  v_lshrrev_b32 v6, 4, v0
  v_lshlrev_b32 v6, 7, v6
  v_add_u32 v6, s78, v6
  s_waitcnt lgkmcnt(0)
  ds_read_b128 v[64:67], v6 offset:0
  ds_read_b128 v[68:71], v6 offset:16
  ds_read_b128 v[92:95], v6 offset:32
  ds_read_b128 v[96:99], v6 offset:48
  ds_read_b128 v[120:123], v6 offset:64
  ds_read_b128 v[124:127], v6 offset:80
  ds_read_b128 v[148:151], v6 offset:96
  ds_read_b128 v[152:155], v6 offset:112
  s_waitcnt lgkmcnt(0)
  v_pk_mul_f32 v[86:87], v[64:65], v[2:3]
  v_pk_mul_f32 v[114:115], v[92:93], v[2:3]
  v_pk_mul_f32 v[142:143], v[120:121], v[2:3]
  v_pk_mul_f32 v[170:171], v[148:149], v[2:3]
  v_pk_mul_f32 v[88:89], v[64:65], v[4:5]
  v_pk_mul_f32 v[116:117], v[92:93], v[4:5]
  v_pk_mul_f32 v[144:145], v[120:121], v[4:5]
  v_pk_mul_f32 v[172:173], v[148:149], v[4:5]
  v_exp_f32 v86, v86
  v_exp_f32 v114, v114
  v_exp_f32 v142, v142
  v_exp_f32 v170, v170
  v_exp_f32 v88, v88
  v_exp_f32 v116, v116
  v_exp_f32 v144, v144
  v_exp_f32 v172, v172
  v_fract_f32 v87, v87
  v_fract_f32 v115, v115
  v_fract_f32 v143, v143
  v_fract_f32 v171, v171
  v_fract_f32 v89, v89
  v_fract_f32 v117, v117
  v_fract_f32 v145, v145
  v_fract_f32 v173, v173
  v_cos_f32 v72, v87
  v_cos_f32 v100, v115
  v_cos_f32 v128, v143
  v_cos_f32 v156, v171
  v_sin_f32 v73, v87
  v_sin_f32 v101, v115
  v_sin_f32 v129, v143
  v_sin_f32 v157, v171
  v_cos_f32 v84, v89
  v_cos_f32 v112, v117
  v_cos_f32 v140, v145
  v_cos_f32 v168, v173
  v_sin_f32 v85, v89
  v_sin_f32 v113, v117
  v_sin_f32 v141, v145
  v_sin_f32 v169, v173
  s_nop 0
  s_nop 0
  s_nop 0
  s_nop 0
  v_pk_mul_f32 v[72:73], v[72:73], v[86:87] op_sel_hi:[1,0]
  v_pk_mul_f32 v[100:101], v[100:101], v[114:115] op_sel_hi:[1,0]
  v_pk_mul_f32 v[128:129], v[128:129], v[142:143] op_sel_hi:[1,0]
  v_pk_mul_f32 v[156:157], v[156:157], v[170:171] op_sel_hi:[1,0]
  v_pk_mul_f32 v[84:85], v[84:85], v[88:89] op_sel_hi:[1,0]
  v_pk_mul_f32 v[112:113], v[112:113], v[116:117] op_sel_hi:[1,0]
  v_pk_mul_f32 v[140:141], v[140:141], v[144:145] op_sel_hi:[1,0]
  v_pk_mul_f32 v[168:169], v[168:169], v[172:173] op_sel_hi:[1,0]
  v_pk_mul_f32 v[74:75], v[72:73], v[68:69] op_sel_hi:[1,0]
  v_pk_mul_f32 v[102:103], v[100:101], v[96:97] op_sel_hi:[1,0]
  v_pk_mul_f32 v[130:131], v[128:129], v[124:125] op_sel_hi:[1,0]
  v_pk_mul_f32 v[158:159], v[156:157], v[152:153] op_sel_hi:[1,0]
  v_pk_fma_f32 v[74:75], v[72:73], v[68:69], v[74:75] op_sel:[1,1,0] op_sel_hi:[0,1,1] neg_lo:[1,0,0]
  v_pk_fma_f32 v[102:103], v[100:101], v[96:97], v[102:103] op_sel:[1,1,0] op_sel_hi:[0,1,1] neg_lo:[1,0,0]
  v_pk_fma_f32 v[130:131], v[128:129], v[124:125], v[130:131] op_sel:[1,1,0] op_sel_hi:[0,1,1] neg_lo:[1,0,0]
  v_pk_fma_f32 v[158:159], v[156:157], v[152:153], v[158:159] op_sel:[1,1,0] op_sel_hi:[0,1,1] neg_lo:[1,0,0]
  v_pk_mul_f32 v[76:77], v[84:85], v[66:67] op_sel_hi:[1,0]
  v_pk_mul_f32 v[104:105], v[112:113], v[94:95] op_sel_hi:[1,0]
  v_pk_mul_f32 v[132:133], v[140:141], v[122:123] op_sel_hi:[1,0]
  v_pk_mul_f32 v[160:161], v[168:169], v[150:151] op_sel_hi:[1,0]
  v_pk_fma_f32 v[76:77], v[84:85], v[66:67], v[76:77] op_sel:[1,1,0] op_sel_hi:[0,1,1] neg_lo:[1,0,0]
  v_pk_fma_f32 v[104:105], v[112:113], v[94:95], v[104:105] op_sel:[1,1,0] op_sel_hi:[0,1,1] neg_lo:[1,0,0]
  v_pk_fma_f32 v[132:133], v[140:141], v[122:123], v[132:133] op_sel:[1,1,0] op_sel_hi:[0,1,1] neg_lo:[1,0,0]
  v_pk_fma_f32 v[160:161], v[168:169], v[150:151], v[160:161] op_sel:[1,1,0] op_sel_hi:[0,1,1] neg_lo:[1,0,0]
  v_pk_mul_f32 v[78:79], v[76:77], v[70:71] op_sel_hi:[1,0]
  v_pk_mul_f32 v[106:107], v[104:105], v[98:99] op_sel_hi:[1,0]
  v_pk_mul_f32 v[134:135], v[132:133], v[126:127] op_sel_hi:[1,0]
  v_pk_mul_f32 v[162:163], v[160:161], v[154:155] op_sel_hi:[1,0]
  v_pk_fma_f32 v[78:79], v[76:77], v[70:71], v[78:79] op_sel:[1,1,0] op_sel_hi:[0,1,1] neg_lo:[1,0,0]
  v_pk_fma_f32 v[106:107], v[104:105], v[98:99], v[106:107] op_sel:[1,1,0] op_sel_hi:[0,1,1] neg_lo:[1,0,0]
  v_pk_fma_f32 v[134:135], v[132:133], v[126:127], v[134:135] op_sel:[1,1,0] op_sel_hi:[0,1,1] neg_lo:[1,0,0]
  v_pk_fma_f32 v[162:163], v[160:161], v[154:155], v[162:163] op_sel:[1,1,0] op_sel_hi:[0,1,1] neg_lo:[1,0,0]
  v_pk_mul_f32 v[80:81], v[78:79], v[70:71] op_sel_hi:[1,0]
  v_pk_mul_f32 v[108:109], v[106:107], v[98:99] op_sel_hi:[1,0]
  v_pk_mul_f32 v[136:137], v[134:135], v[126:127] op_sel_hi:[1,0]
  v_pk_mul_f32 v[164:165], v[162:163], v[154:155] op_sel_hi:[1,0]
  v_pk_fma_f32 v[80:81], v[78:79], v[70:71], v[80:81] op_sel:[1,1,0] op_sel_hi:[0,1,1] neg_lo:[1,0,0]
  v_pk_fma_f32 v[108:109], v[106:107], v[98:99], v[108:109] op_sel:[1,1,0] op_sel_hi:[0,1,1] neg_lo:[1,0,0]
  v_pk_fma_f32 v[136:137], v[134:135], v[126:127], v[136:137] op_sel:[1,1,0] op_sel_hi:[0,1,1] neg_lo:[1,0,0]
  v_pk_fma_f32 v[164:165], v[162:163], v[154:155], v[164:165] op_sel:[1,1,0] op_sel_hi:[0,1,1] neg_lo:[1,0,0]
  v_pk_mul_f32 v[82:83], v[80:81], v[70:71] op_sel_hi:[1,0]
  v_pk_mul_f32 v[110:111], v[108:109], v[98:99] op_sel_hi:[1,0]
  v_pk_mul_f32 v[138:139], v[136:137], v[126:127] op_sel_hi:[1,0]
  v_pk_mul_f32 v[166:167], v[164:165], v[154:155] op_sel_hi:[1,0]
  v_pk_fma_f32 v[82:83], v[80:81], v[70:71], v[82:83] op_sel:[1,1,0] op_sel_hi:[0,1,1] neg_lo:[1,0,0]
  v_pk_fma_f32 v[110:111], v[108:109], v[98:99], v[110:111] op_sel:[1,1,0] op_sel_hi:[0,1,1] neg_lo:[1,0,0]
  v_pk_fma_f32 v[138:139], v[136:137], v[126:127], v[138:139] op_sel:[1,1,0] op_sel_hi:[0,1,1] neg_lo:[1,0,0]
  v_pk_fma_f32 v[166:167], v[164:165], v[154:155], v[166:167] op_sel:[1,1,0] op_sel_hi:[0,1,1] neg_lo:[1,0,0]
  v_cvt_pk_bf16_f32 v16, v72, -v73
  v_cvt_pk_bf16_f32 v17, v100, -v101
  v_cvt_pk_bf16_f32 v18, v128, -v129
  v_cvt_pk_bf16_f32 v19, v156, -v157
  v_lshlrev_b32 v86, 16, v16
  v_lshlrev_b32 v114, 16, v17
  v_lshlrev_b32 v142, 16, v18
  v_lshlrev_b32 v170, 16, v19
  v_and_b32 v87, 0xffff0000, v16
  v_and_b32 v115, 0xffff0000, v17
  v_and_b32 v143, 0xffff0000, v18
  v_and_b32 v171, 0xffff0000, v19
  v_pk_add_f32 v[86:87], v[72:73], v[86:87] neg_lo:[0,1] neg_hi:[1,1]
  v_pk_add_f32 v[114:115], v[100:101], v[114:115] neg_lo:[0,1] neg_hi:[1,1]
  v_pk_add_f32 v[142:143], v[128:129], v[142:143] neg_lo:[0,1] neg_hi:[1,1]
  v_pk_add_f32 v[170:171], v[156:157], v[170:171] neg_lo:[0,1] neg_hi:[1,1]
  v_cvt_pk_bf16_f32 v20, v86, v87
  v_cvt_pk_bf16_f32 v21, v114, v115
  v_cvt_pk_bf16_f32 v22, v142, v143
  v_cvt_pk_bf16_f32 v23, v170, v171
  v_cvt_pk_bf16_f32 v24, v74, -v75
  v_cvt_pk_bf16_f32 v25, v102, -v103
  v_cvt_pk_bf16_f32 v26, v130, -v131
  v_cvt_pk_bf16_f32 v27, v158, -v159
  v_lshlrev_b32 v88, 16, v24
  v_lshlrev_b32 v116, 16, v25
  v_lshlrev_b32 v144, 16, v26
  v_lshlrev_b32 v172, 16, v27
  v_and_b32 v89, 0xffff0000, v24
  v_and_b32 v117, 0xffff0000, v25
  v_and_b32 v145, 0xffff0000, v26
  v_and_b32 v173, 0xffff0000, v27
  v_pk_add_f32 v[88:89], v[74:75], v[88:89] neg_lo:[0,1] neg_hi:[1,1]
  v_pk_add_f32 v[116:117], v[102:103], v[116:117] neg_lo:[0,1] neg_hi:[1,1]
  v_pk_add_f32 v[144:145], v[130:131], v[144:145] neg_lo:[0,1] neg_hi:[1,1]
  v_pk_add_f32 v[172:173], v[158:159], v[172:173] neg_lo:[0,1] neg_hi:[1,1]
  v_cvt_pk_bf16_f32 v28, v88, v89
  v_cvt_pk_bf16_f32 v29, v116, v117
  v_cvt_pk_bf16_f32 v30, v144, v145
  v_cvt_pk_bf16_f32 v31, v172, v173
  v_cvt_pk_bf16_f32 v32, v76, v77
  v_cvt_pk_bf16_f32 v33, v104, v105
  v_cvt_pk_bf16_f32 v34, v132, v133
  v_cvt_pk_bf16_f32 v35, v160, v161
  v_lshlrev_b32 v90, 16, v32
  v_lshlrev_b32 v118, 16, v33
  v_lshlrev_b32 v146, 16, v34
  v_lshlrev_b32 v174, 16, v35
  v_and_b32 v91, 0xffff0000, v32
  v_and_b32 v119, 0xffff0000, v33
  v_and_b32 v147, 0xffff0000, v34
  v_and_b32 v175, 0xffff0000, v35
  v_pk_add_f32 v[90:91], v[76:77], v[90:91] neg_lo:[0,1] neg_hi:[0,1]
  v_pk_add_f32 v[118:119], v[104:105], v[118:119] neg_lo:[0,1] neg_hi:[0,1]
  v_pk_add_f32 v[146:147], v[132:133], v[146:147] neg_lo:[0,1] neg_hi:[0,1]
  v_pk_add_f32 v[174:175], v[160:161], v[174:175] neg_lo:[0,1] neg_hi:[0,1]
  v_cvt_pk_bf16_f32 v36, v90, v91
  v_cvt_pk_bf16_f32 v37, v118, v119
  v_cvt_pk_bf16_f32 v38, v146, v147
  v_cvt_pk_bf16_f32 v39, v174, v175
  v_cvt_pk_bf16_f32 v40, v78, v79
  v_cvt_pk_bf16_f32 v41, v106, v107
  v_cvt_pk_bf16_f32 v42, v134, v135
  v_cvt_pk_bf16_f32 v43, v162, v163
  v_lshlrev_b32 v86, 16, v40
  v_lshlrev_b32 v114, 16, v41
  v_lshlrev_b32 v142, 16, v42
  v_lshlrev_b32 v170, 16, v43
  v_and_b32 v87, 0xffff0000, v40
  v_and_b32 v115, 0xffff0000, v41
  v_and_b32 v143, 0xffff0000, v42
  v_and_b32 v171, 0xffff0000, v43
  v_pk_add_f32 v[86:87], v[78:79], v[86:87] neg_lo:[0,1] neg_hi:[0,1]
  v_pk_add_f32 v[114:115], v[106:107], v[114:115] neg_lo:[0,1] neg_hi:[0,1]
  v_pk_add_f32 v[142:143], v[134:135], v[142:143] neg_lo:[0,1] neg_hi:[0,1]
  v_pk_add_f32 v[170:171], v[162:163], v[170:171] neg_lo:[0,1] neg_hi:[0,1]
  v_cvt_pk_bf16_f32 v44, v86, v87
  v_cvt_pk_bf16_f32 v45, v114, v115
  v_cvt_pk_bf16_f32 v46, v142, v143
  v_cvt_pk_bf16_f32 v47, v170, v171
  v_cvt_pk_bf16_f32 v48, v80, v81
  v_cvt_pk_bf16_f32 v49, v108, v109
  v_cvt_pk_bf16_f32 v50, v136, v137
  v_cvt_pk_bf16_f32 v51, v164, v165
  v_lshlrev_b32 v88, 16, v48
  v_lshlrev_b32 v116, 16, v49
  v_lshlrev_b32 v144, 16, v50
  v_lshlrev_b32 v172, 16, v51
  v_and_b32 v89, 0xffff0000, v48
  v_and_b32 v117, 0xffff0000, v49
  v_and_b32 v145, 0xffff0000, v50
  v_and_b32 v173, 0xffff0000, v51
  v_pk_add_f32 v[88:89], v[80:81], v[88:89] neg_lo:[0,1] neg_hi:[0,1]
  v_pk_add_f32 v[116:117], v[108:109], v[116:117] neg_lo:[0,1] neg_hi:[0,1]
  v_pk_add_f32 v[144:145], v[136:137], v[144:145] neg_lo:[0,1] neg_hi:[0,1]
  v_pk_add_f32 v[172:173], v[164:165], v[172:173] neg_lo:[0,1] neg_hi:[0,1]
  v_cvt_pk_bf16_f32 v52, v88, v89
  v_cvt_pk_bf16_f32 v53, v116, v117
  v_cvt_pk_bf16_f32 v54, v144, v145
  v_cvt_pk_bf16_f32 v55, v172, v173
  v_cvt_pk_bf16_f32 v56, v82, v83
  v_cvt_pk_bf16_f32 v57, v110, v111
  v_cvt_pk_bf16_f32 v58, v138, v139
  v_cvt_pk_bf16_f32 v59, v166, v167
  v_lshlrev_b32 v90, 16, v56
  v_lshlrev_b32 v118, 16, v57
  v_lshlrev_b32 v146, 16, v58
  v_lshlrev_b32 v174, 16, v59
  v_and_b32 v91, 0xffff0000, v56
  v_and_b32 v119, 0xffff0000, v57
  v_and_b32 v147, 0xffff0000, v58
  v_and_b32 v175, 0xffff0000, v59
  v_pk_add_f32 v[90:91], v[82:83], v[90:91] neg_lo:[0,1] neg_hi:[0,1]
  v_pk_add_f32 v[118:119], v[110:111], v[118:119] neg_lo:[0,1] neg_hi:[0,1]
  v_pk_add_f32 v[146:147], v[138:139], v[146:147] neg_lo:[0,1] neg_hi:[0,1]
  v_pk_add_f32 v[174:175], v[166:167], v[174:175] neg_lo:[0,1] neg_hi:[0,1]
  v_cvt_pk_bf16_f32 v60, v90, v91
  v_cvt_pk_bf16_f32 v61, v118, v119
  v_cvt_pk_bf16_f32 v62, v146, v147
  v_cvt_pk_bf16_f32 v63, v174, v175
  s_nop 1
  v_mfma_f32_16x16x32_bf16 v[192:195], v[16:19], v[32:35], v[192:195]
  v_mfma_f32_16x16x32_bf16 v[196:199], v[24:27], v[32:35], v[196:199]
  v_mfma_f32_16x16x32_bf16 v[200:203], v[16:19], v[40:43], v[200:203]
  v_mfma_f32_16x16x32_bf16 v[204:207], v[24:27], v[40:43], v[204:207]
  v_mfma_f32_16x16x32_bf16 v[208:211], v[16:19], v[48:51], v[208:211]
  v_mfma_f32_16x16x32_bf16 v[212:215], v[24:27], v[48:51], v[212:215]
  v_mfma_f32_16x16x32_bf16 v[216:219], v[16:19], v[56:59], v[216:219]
  v_mfma_f32_16x16x32_bf16 v[220:223], v[24:27], v[56:59], v[220:223]
  v_mfma_f32_16x16x32_bf16 v[192:195], v[20:23], v[32:35], v[192:195]
  v_mfma_f32_16x16x32_bf16 v[196:199], v[28:31], v[32:35], v[196:199]
  v_mfma_f32_16x16x32_bf16 v[200:203], v[20:23], v[40:43], v[200:203]
  v_mfma_f32_16x16x32_bf16 v[204:207], v[28:31], v[40:43], v[204:207]
  v_mfma_f32_16x16x32_bf16 v[208:211], v[20:23], v[48:51], v[208:211]
  v_mfma_f32_16x16x32_bf16 v[212:215], v[28:31], v[48:51], v[212:215]
  v_mfma_f32_16x16x32_bf16 v[216:219], v[20:23], v[56:59], v[216:219]
  v_mfma_f32_16x16x32_bf16 v[220:223], v[28:31], v[56:59], v[220:223]
  v_mfma_f32_16x16x32_bf16 v[192:195], v[16:19], v[36:39], v[192:195]
  v_mfma_f32_16x16x32_bf16 v[196:199], v[24:27], v[36:39], v[196:199]
  v_mfma_f32_16x16x32_bf16 v[200:203], v[16:19], v[44:47], v[200:203]
  v_mfma_f32_16x16x32_bf16 v[204:207], v[24:27], v[44:47], v[204:207]
  v_mfma_f32_16x16x32_bf16 v[208:211], v[16:19], v[52:55], v[208:211]
  v_mfma_f32_16x16x32_bf16 v[212:215], v[24:27], v[52:55], v[212:215]
  v_mfma_f32_16x16x32_bf16 v[216:219], v[16:19], v[60:63], v[216:219]
  v_mfma_f32_16x16x32_bf16 v[220:223], v[24:27], v[60:63], v[220:223]
  s_and_b32 s6, s5, 3
  s_lshl_b32 s6, s6, 7
  s_lshl_b32 s7, s50, 5
  s_add_u32 s6, s6, s7
  s_add_u32 s6, s6, 0
  v_lshrrev_b32 v180, 2, v0
  v_add_u32 v180, s6, v180
  v_mul_u32_u24 v180, 3584, v180
  v_and_b32 v181, 3, v0
  v_mul_u32_u24 v181, 72, v181
  v_and_b32 v181, 0xfc, v181
  v_add_u32 v180, v180, v181
  s_mul_i32 s6, s49, 224
  v_add_u32 v180, s6, v180
  global_load_dword v243, v180, s[36:37]
  global_load_dword v243, v180, s[38:39]
  s_and_b32 s6, s5, 3
  s_lshl_b32 s6, s6, 7
  s_lshl_b32 s7, s50, 5
  s_add_u32 s6, s6, s7
  s_add_u32 s6, s6, 16
  v_lshrrev_b32 v180, 2, v0
  v_add_u32 v180, s6, v180
  v_mul_u32_u24 v180, 3584, v180
  v_and_b32 v181, 3, v0
  v_mul_u32_u24 v181, 72, v181
  v_and_b32 v181, 0xfc, v181
  v_add_u32 v180, v180, v181
  s_mul_i32 s6, s49, 224
  v_add_u32 v180, s6, v180
  global_load_dword v243, v180, s[36:37]
  global_load_dword v243, v180, s[38:39]
  ds_read_b128 v[64:67], v6 offset:512
  ds_read_b128 v[68:71], v6 offset:528
  ds_read_b128 v[92:95], v6 offset:544
  ds_read_b128 v[96:99], v6 offset:560
  ds_read_b128 v[120:123], v6 offset:576
  ds_read_b128 v[124:127], v6 offset:592
  ds_read_b128 v[148:151], v6 offset:608
  ds_read_b128 v[152:155], v6 offset:624
  s_waitcnt lgkmcnt(0)
  v_pk_mul_f32 v[86:87], v[64:65], v[2:3]
  v_pk_mul_f32 v[114:115], v[92:93], v[2:3]
  v_pk_mul_f32 v[142:143], v[120:121], v[2:3]
  v_pk_mul_f32 v[170:171], v[148:149], v[2:3]
  v_pk_mul_f32 v[88:89], v[64:65], v[4:5]
  v_pk_mul_f32 v[116:117], v[92:93], v[4:5]
  v_pk_mul_f32 v[144:145], v[120:121], v[4:5]
  v_pk_mul_f32 v[172:173], v[148:149], v[4:5]
  v_exp_f32 v86, v86
  v_exp_f32 v114, v114
  v_exp_f32 v142, v142
  v_exp_f32 v170, v170
  v_exp_f32 v88, v88
  v_exp_f32 v116, v116
  v_exp_f32 v144, v144
  v_exp_f32 v172, v172
  v_fract_f32 v87, v87
  v_fract_f32 v115, v115
  v_fract_f32 v143, v143
  v_fract_f32 v171, v171
  v_fract_f32 v89, v89
  v_fract_f32 v117, v117
  v_fract_f32 v145, v145
  v_fract_f32 v173, v173
  v_cos_f32 v72, v87
  v_cos_f32 v100, v115
  v_cos_f32 v128, v143
  v_cos_f32 v156, v171
  v_sin_f32 v73, v87
  v_sin_f32 v101, v115
  v_sin_f32 v129, v143
  v_sin_f32 v157, v171
  v_cos_f32 v84, v89
  v_cos_f32 v112, v117
  v_cos_f32 v140, v145
  v_cos_f32 v168, v173
  v_sin_f32 v85, v89
  v_sin_f32 v113, v117
  v_sin_f32 v141, v145
  v_sin_f32 v169, v173
  s_nop 0
  s_nop 0
  s_nop 0
  s_nop 0
  v_pk_mul_f32 v[72:73], v[72:73], v[86:87] op_sel_hi:[1,0]
  v_pk_mul_f32 v[100:101], v[100:101], v[114:115] op_sel_hi:[1,0]
  v_pk_mul_f32 v[128:129], v[128:129], v[142:143] op_sel_hi:[1,0]
  v_pk_mul_f32 v[156:157], v[156:157], v[170:171] op_sel_hi:[1,0]
  v_pk_mul_f32 v[84:85], v[84:85], v[88:89] op_sel_hi:[1,0]
  v_pk_mul_f32 v[112:113], v[112:113], v[116:117] op_sel_hi:[1,0]
  v_pk_mul_f32 v[140:141], v[140:141], v[144:145] op_sel_hi:[1,0]
  v_pk_mul_f32 v[168:169], v[168:169], v[172:173] op_sel_hi:[1,0]
  v_pk_mul_f32 v[74:75], v[72:73], v[68:69] op_sel_hi:[1,0]
  v_pk_mul_f32 v[102:103], v[100:101], v[96:97] op_sel_hi:[1,0]
  v_pk_mul_f32 v[130:131], v[128:129], v[124:125] op_sel_hi:[1,0]
  v_pk_mul_f32 v[158:159], v[156:157], v[152:153] op_sel_hi:[1,0]
  v_pk_fma_f32 v[74:75], v[72:73], v[68:69], v[74:75] op_sel:[1,1,0] op_sel_hi:[0,1,1] neg_lo:[1,0,0]
  v_pk_fma_f32 v[102:103], v[100:101], v[96:97], v[102:103] op_sel:[1,1,0] op_sel_hi:[0,1,1] neg_lo:[1,0,0]
  v_pk_fma_f32 v[130:131], v[128:129], v[124:125], v[130:131] op_sel:[1,1,0] op_sel_hi:[0,1,1] neg_lo:[1,0,0]
  v_pk_fma_f32 v[158:159], v[156:157], v[152:153], v[158:159] op_sel:[1,1,0] op_sel_hi:[0,1,1] neg_lo:[1,0,0]
  v_pk_mul_f32 v[76:77], v[84:85], v[66:67] op_sel_hi:[1,0]
  v_pk_mul_f32 v[104:105], v[112:113], v[94:95] op_sel_hi:[1,0]
  v_pk_mul_f32 v[132:133], v[140:141], v[122:123] op_sel_hi:[1,0]
  v_pk_mul_f32 v[160:161], v[168:169], v[150:151] op_sel_hi:[1,0]
  v_pk_fma_f32 v[76:77], v[84:85], v[66:67], v[76:77] op_sel:[1,1,0] op_sel_hi:[0,1,1] neg_lo:[1,0,0]
  v_pk_fma_f32 v[104:105], v[112:113], v[94:95], v[104:105] op_sel:[1,1,0] op_sel_hi:[0,1,1] neg_lo:[1,0,0]
  v_pk_fma_f32 v[132:133], v[140:141], v[122:123], v[132:133] op_sel:[1,1,0] op_sel_hi:[0,1,1] neg_lo:[1,0,0]
  v_pk_fma_f32 v[160:161], v[168:169], v[150:151], v[160:161] op_sel:[1,1,0] op_sel_hi:[0,1,1] neg_lo:[1,0,0]
  v_pk_mul_f32 v[78:79], v[76:77], v[70:71] op_sel_hi:[1,0]
  v_pk_mul_f32 v[106:107], v[104:105], v[98:99] op_sel_hi:[1,0]
  v_pk_mul_f32 v[134:135], v[132:133], v[126:127] op_sel_hi:[1,0]
  v_pk_mul_f32 v[162:163], v[160:161], v[154:155] op_sel_hi:[1,0]
  v_pk_fma_f32 v[78:79], v[76:77], v[70:71], v[78:79] op_sel:[1,1,0] op_sel_hi:[0,1,1] neg_lo:[1,0,0]
  v_pk_fma_f32 v[106:107], v[104:105], v[98:99], v[106:107] op_sel:[1,1,0] op_sel_hi:[0,1,1] neg_lo:[1,0,0]
  v_pk_fma_f32 v[134:135], v[132:133], v[126:127], v[134:135] op_sel:[1,1,0] op_sel_hi:[0,1,1] neg_lo:[1,0,0]
  v_pk_fma_f32 v[162:163], v[160:161], v[154:155], v[162:163] op_sel:[1,1,0] op_sel_hi:[0,1,1] neg_lo:[1,0,0]
  v_pk_mul_f32 v[80:81], v[78:79], v[70:71] op_sel_hi:[1,0]
  v_pk_mul_f32 v[108:109], v[106:107], v[98:99] op_sel_hi:[1,0]
  v_pk_mul_f32 v[136:137], v[134:135], v[126:127] op_sel_hi:[1,0]
  v_pk_mul_f32 v[164:165], v[162:163], v[154:155] op_sel_hi:[1,0]
  v_pk_fma_f32 v[80:81], v[78:79], v[70:71], v[80:81] op_sel:[1,1,0] op_sel_hi:[0,1,1] neg_lo:[1,0,0]
  v_pk_fma_f32 v[108:109], v[106:107], v[98:99], v[108:109] op_sel:[1,1,0] op_sel_hi:[0,1,1] neg_lo:[1,0,0]
  v_pk_fma_f32 v[136:137], v[134:135], v[126:127], v[136:137] op_sel:[1,1,0] op_sel_hi:[0,1,1] neg_lo:[1,0,0]
  v_pk_fma_f32 v[164:165], v[162:163], v[154:155], v[164:165] op_sel:[1,1,0] op_sel_hi:[0,1,1] neg_lo:[1,0,0]
  v_pk_mul_f32 v[82:83], v[80:81], v[70:71] op_sel_hi:[1,0]
  v_pk_mul_f32 v[110:111], v[108:109], v[98:99] op_sel_hi:[1,0]
  v_pk_mul_f32 v[138:139], v[136:137], v[126:127] op_sel_hi:[1,0]
  v_pk_mul_f32 v[166:167], v[164:165], v[154:155] op_sel_hi:[1,0]
  v_pk_fma_f32 v[82:83], v[80:81], v[70:71], v[82:83] op_sel:[1,1,0] op_sel_hi:[0,1,1] neg_lo:[1,0,0]
  v_pk_fma_f32 v[110:111], v[108:109], v[98:99], v[110:111] op_sel:[1,1,0] op_sel_hi:[0,1,1] neg_lo:[1,0,0]
  v_pk_fma_f32 v[138:139], v[136:137], v[126:127], v[138:139] op_sel:[1,1,0] op_sel_hi:[0,1,1] neg_lo:[1,0,0]
  v_pk_fma_f32 v[166:167], v[164:165], v[154:155], v[166:167] op_sel:[1,1,0] op_sel_hi:[0,1,1] neg_lo:[1,0,0]
  v_cvt_pk_bf16_f32 v16, v72, -v73
  v_cvt_pk_bf16_f32 v17, v100, -v101
  v_cvt_pk_bf16_f32 v18, v128, -v129
  v_cvt_pk_bf16_f32 v19, v156, -v157
  v_lshlrev_b32 v86, 16, v16
  v_lshlrev_b32 v114, 16, v17
  v_lshlrev_b32 v142, 16, v18
  v_lshlrev_b32 v170, 16, v19
  v_and_b32 v87, 0xffff0000, v16
  v_and_b32 v115, 0xffff0000, v17
  v_and_b32 v143, 0xffff0000, v18
  v_and_b32 v171, 0xffff0000, v19
  v_pk_add_f32 v[86:87], v[72:73], v[86:87] neg_lo:[0,1] neg_hi:[1,1]
  v_pk_add_f32 v[114:115], v[100:101], v[114:115] neg_lo:[0,1] neg_hi:[1,1]
  v_pk_add_f32 v[142:143], v[128:129], v[142:143] neg_lo:[0,1] neg_hi:[1,1]
  v_pk_add_f32 v[170:171], v[156:157], v[170:171] neg_lo:[0,1] neg_hi:[1,1]
  v_cvt_pk_bf16_f32 v20, v86, v87
  v_cvt_pk_bf16_f32 v21, v114, v115
  v_cvt_pk_bf16_f32 v22, v142, v143
  v_cvt_pk_bf16_f32 v23, v170, v171
  v_cvt_pk_bf16_f32 v24, v74, -v75
  v_cvt_pk_bf16_f32 v25, v102, -v103
  v_cvt_pk_bf16_f32 v26, v130, -v131
  v_cvt_pk_bf16_f32 v27, v158, -v159
  v_lshlrev_b32 v88, 16, v24
  v_lshlrev_b32 v116, 16, v25
  v_lshlrev_b32 v144, 16, v26
  v_lshlrev_b32 v172, 16, v27
  v_and_b32 v89, 0xffff0000, v24
  v_and_b32 v117, 0xffff0000, v25
  v_and_b32 v145, 0xffff0000, v26
  v_and_b32 v173, 0xffff0000, v27
  v_pk_add_f32 v[88:89], v[74:75], v[88:89] neg_lo:[0,1] neg_hi:[1,1]
  v_pk_add_f32 v[116:117], v[102:103], v[116:117] neg_lo:[0,1] neg_hi:[1,1]
  v_pk_add_f32 v[144:145], v[130:131], v[144:145] neg_lo:[0,1] neg_hi:[1,1]
  v_pk_add_f32 v[172:173], v[158:159], v[172:173] neg_lo:[0,1] neg_hi:[1,1]
  v_cvt_pk_bf16_f32 v28, v88, v89
  v_cvt_pk_bf16_f32 v29, v116, v117
  v_cvt_pk_bf16_f32 v30, v144, v145
  v_cvt_pk_bf16_f32 v31, v172, v173
  v_cvt_pk_bf16_f32 v32, v76, v77
  v_cvt_pk_bf16_f32 v33, v104, v105
  v_cvt_pk_bf16_f32 v34, v132, v133
  v_cvt_pk_bf16_f32 v35, v160, v161
  v_lshlrev_b32 v90, 16, v32
  v_lshlrev_b32 v118, 16, v33
  v_lshlrev_b32 v146, 16, v34
  v_lshlrev_b32 v174, 16, v35
  v_and_b32 v91, 0xffff0000, v32
  v_and_b32 v119, 0xffff0000, v33
  v_and_b32 v147, 0xffff0000, v34
  v_and_b32 v175, 0xffff0000, v35
  v_pk_add_f32 v[90:91], v[76:77], v[90:91] neg_lo:[0,1] neg_hi:[0,1]
  v_pk_add_f32 v[118:119], v[104:105], v[118:119] neg_lo:[0,1] neg_hi:[0,1]
  v_pk_add_f32 v[146:147], v[132:133], v[146:147] neg_lo:[0,1] neg_hi:[0,1]
  v_pk_add_f32 v[174:175], v[160:161], v[174:175] neg_lo:[0,1] neg_hi:[0,1]
  v_cvt_pk_bf16_f32 v36, v90, v91
  v_cvt_pk_bf16_f32 v37, v118, v119
  v_cvt_pk_bf16_f32 v38, v146, v147
  v_cvt_pk_bf16_f32 v39, v174, v175
  v_cvt_pk_bf16_f32 v40, v78, v79
  v_cvt_pk_bf16_f32 v41, v106, v107
  v_cvt_pk_bf16_f32 v42, v134, v135
  v_cvt_pk_bf16_f32 v43, v162, v163
  v_lshlrev_b32 v86, 16, v40
  v_lshlrev_b32 v114, 16, v41
  v_lshlrev_b32 v142, 16, v42
  v_lshlrev_b32 v170, 16, v43
  v_and_b32 v87, 0xffff0000, v40
  v_and_b32 v115, 0xffff0000, v41
  v_and_b32 v143, 0xffff0000, v42
  v_and_b32 v171, 0xffff0000, v43
  v_pk_add_f32 v[86:87], v[78:79], v[86:87] neg_lo:[0,1] neg_hi:[0,1]
  v_pk_add_f32 v[114:115], v[106:107], v[114:115] neg_lo:[0,1] neg_hi:[0,1]
  v_pk_add_f32 v[142:143], v[134:135], v[142:143] neg_lo:[0,1] neg_hi:[0,1]
  v_pk_add_f32 v[170:171], v[162:163], v[170:171] neg_lo:[0,1] neg_hi:[0,1]
  v_cvt_pk_bf16_f32 v44, v86, v87
  v_cvt_pk_bf16_f32 v45, v114, v115
  v_cvt_pk_bf16_f32 v46, v142, v143
  v_cvt_pk_bf16_f32 v47, v170, v171
  v_cvt_pk_bf16_f32 v48, v80, v81
  v_cvt_pk_bf16_f32 v49, v108, v109
  v_cvt_pk_bf16_f32 v50, v136, v137
  v_cvt_pk_bf16_f32 v51, v164, v165
  v_lshlrev_b32 v88, 16, v48
  v_lshlrev_b32 v116, 16, v49
  v_lshlrev_b32 v144, 16, v50
  v_lshlrev_b32 v172, 16, v51
  v_and_b32 v89, 0xffff0000, v48
  v_and_b32 v117, 0xffff0000, v49
  v_and_b32 v145, 0xffff0000, v50
  v_and_b32 v173, 0xffff0000, v51
  v_pk_add_f32 v[88:89], v[80:81], v[88:89] neg_lo:[0,1] neg_hi:[0,1]
  v_pk_add_f32 v[116:117], v[108:109], v[116:117] neg_lo:[0,1] neg_hi:[0,1]
  v_pk_add_f32 v[144:145], v[136:137], v[144:145] neg_lo:[0,1] neg_hi:[0,1]
  v_pk_add_f32 v[172:173], v[164:165], v[172:173] neg_lo:[0,1] neg_hi:[0,1]
  v_cvt_pk_bf16_f32 v52, v88, v89
  v_cvt_pk_bf16_f32 v53, v116, v117
  v_cvt_pk_bf16_f32 v54, v144, v145
  v_cvt_pk_bf16_f32 v55, v172, v173
  v_cvt_pk_bf16_f32 v56, v82, v83
  v_cvt_pk_bf16_f32 v57, v110, v111
  v_cvt_pk_bf16_f32 v58, v138, v139
  v_cvt_pk_bf16_f32 v59, v166, v167
  v_lshlrev_b32 v90, 16, v56
  v_lshlrev_b32 v118, 16, v57
  v_lshlrev_b32 v146, 16, v58
  v_lshlrev_b32 v174, 16, v59
  v_and_b32 v91, 0xffff0000, v56
  v_and_b32 v119, 0xffff0000, v57
  v_and_b32 v147, 0xffff0000, v58
  v_and_b32 v175, 0xffff0000, v59
  v_pk_add_f32 v[90:91], v[82:83], v[90:91] neg_lo:[0,1] neg_hi:[0,1]
  v_pk_add_f32 v[118:119], v[110:111], v[118:119] neg_lo:[0,1] neg_hi:[0,1]
  v_pk_add_f32 v[146:147], v[138:139], v[146:147] neg_lo:[0,1] neg_hi:[0,1]
  v_pk_add_f32 v[174:175], v[166:167], v[174:175] neg_lo:[0,1] neg_hi:[0,1]
  v_cvt_pk_bf16_f32 v60, v90, v91
  v_cvt_pk_bf16_f32 v61, v118, v119
  v_cvt_pk_bf16_f32 v62, v146, v147
  v_cvt_pk_bf16_f32 v63, v174, v175
  s_nop 1
  v_mfma_f32_16x16x32_bf16 v[192:195], v[16:19], v[32:35], v[192:195]
  v_mfma_f32_16x16x32_bf16 v[196:199], v[24:27], v[32:35], v[196:199]
  v_mfma_f32_16x16x32_bf16 v[200:203], v[16:19], v[40:43], v[200:203]
  v_mfma_f32_16x16x32_bf16 v[204:207], v[24:27], v[40:43], v[204:207]
  v_mfma_f32_16x16x32_bf16 v[208:211], v[16:19], v[48:51], v[208:211]
  v_mfma_f32_16x16x32_bf16 v[212:215], v[24:27], v[48:51], v[212:215]
  v_mfma_f32_16x16x32_bf16 v[216:219], v[16:19], v[56:59], v[216:219]
  v_mfma_f32_16x16x32_bf16 v[220:223], v[24:27], v[56:59], v[220:223]
  v_mfma_f32_16x16x32_bf16 v[192:195], v[20:23], v[32:35], v[192:195]
  v_mfma_f32_16x16x32_bf16 v[196:199], v[28:31], v[32:35], v[196:199]
  v_mfma_f32_16x16x32_bf16 v[200:203], v[20:23], v[40:43], v[200:203]
  v_mfma_f32_16x16x32_bf16 v[204:207], v[28:31], v[40:43], v[204:207]
  v_mfma_f32_16x16x32_bf16 v[208:211], v[20:23], v[48:51], v[208:211]
  v_mfma_f32_16x16x32_bf16 v[212:215], v[28:31], v[48:51], v[212:215]
  v_mfma_f32_16x16x32_bf16 v[216:219], v[20:23], v[56:59], v[216:219]
  v_mfma_f32_16x16x32_bf16 v[220:223], v[28:31], v[56:59], v[220:223]
  v_mfma_f32_16x16x32_bf16 v[192:195], v[16:19], v[36:39], v[192:195]
  v_mfma_f32_16x16x32_bf16 v[196:199], v[24:27], v[36:39], v[196:199]
  v_mfma_f32_16x16x32_bf16 v[200:203], v[16:19], v[44:47], v[200:203]
  v_mfma_f32_16x16x32_bf16 v[204:207], v[24:27], v[44:47], v[204:207]
  v_mfma_f32_16x16x32_bf16 v[208:211], v[16:19], v[52:55], v[208:211]
  v_mfma_f32_16x16x32_bf16 v[212:215], v[24:27], v[52:55], v[212:215]
  v_mfma_f32_16x16x32_bf16 v[216:219], v[16:19], v[60:63], v[216:219]
  v_mfma_f32_16x16x32_bf16 v[220:223], v[24:27], v[60:63], v[220:223]
  v_and_b32 v1, 15, v0
  v_mul_u32_u24 v1, 144, v1
  v_lshrrev_b32 v4, 4, v0
  v_lshl_add_u32 v1, v4, 4, v1
  v_add_u32 v1, s78, v1
  s_lshl_b32 s73, s71, 6
  v_add_u32 v7, s73, v0
  v_sub_u32 v2, 2047, v7
  v_subrev_u32 v8, 0, v2
  v_cvt_f32_u32 v8, v8
  v_cvt_pk_bf16_f32 v8, v8, v8
  v_lshlrev_b32 v8, 16, v8
  v_cvt_u32_f32 v8, v8
  v_lshrrev_b32 v9, 5, v8
  v_and_b32 v10, 31, v8
  v_mul_u32_u24 v9, 144, v9
  v_lshl_add_u32 v64, v10, 2, v9
  v_subrev_u32 v8, 256, v2
  v_cvt_f32_u32 v8, v8
  v_cvt_pk_bf16_f32 v8, v8, v8
  v_lshlrev_b32 v8, 16, v8
  v_cvt_u32_f32 v8, v8
  v_lshrrev_b32 v9, 5, v8
  v_and_b32 v10, 31, v8
  v_mul_u32_u24 v9, 144, v9
  v_lshl_add_u32 v65, v10, 2, v9
  v_subrev_u32 v8, 512, v2
  v_cvt_f32_u32 v8, v8
  v_cvt_pk_bf16_f32 v8, v8, v8
  v_lshlrev_b32 v8, 16, v8
  v_cvt_u32_f32 v8, v8
  v_lshrrev_b32 v9, 5, v8
  v_and_b32 v10, 31, v8
  v_mul_u32_u24 v9, 144, v9
  v_lshl_add_u32 v66, v10, 2, v9
  v_subrev_u32 v8, 768, v2
  v_cvt_f32_u32 v8, v8
  v_cvt_pk_bf16_f32 v8, v8, v8
  v_lshlrev_b32 v8, 16, v8
  v_cvt_u32_f32 v8, v8
  v_lshrrev_b32 v9, 5, v8
  v_and_b32 v10, 31, v8
  v_mul_u32_u24 v9, 144, v9
  v_lshl_add_u32 v67, v10, 2, v9
  v_subrev_u32 v8, 1024, v2
  v_cvt_f32_u32 v8, v8
  v_cvt_pk_bf16_f32 v8, v8, v8
  v_lshlrev_b32 v8, 16, v8
  v_cvt_u32_f32 v8, v8
  v_lshrrev_b32 v9, 5, v8
  v_and_b32 v10, 31, v8
  v_mul_u32_u24 v9, 144, v9
  v_lshl_add_u32 v68, v10, 2, v9
  v_subrev_u32 v8, 1280, v2
  v_cvt_f32_u32 v8, v8
  v_cvt_pk_bf16_f32 v8, v8, v8
  v_lshlrev_b32 v8, 16, v8
  v_cvt_u32_f32 v8, v8
  v_lshrrev_b32 v9, 5, v8
  v_and_b32 v10, 31, v8
  v_mul_u32_u24 v9, 144, v9
  v_lshl_add_u32 v69, v10, 2, v9
  v_subrev_u32 v8, 1536, v2
  v_cvt_f32_u32 v8, v8
  v_cvt_pk_bf16_f32 v8, v8, v8
  v_lshlrev_b32 v8, 16, v8
  v_cvt_u32_f32 v8, v8
  v_lshrrev_b32 v9, 5, v8
  v_and_b32 v10, 31, v8
  v_mul_u32_u24 v9, 144, v9
  v_lshl_add_u32 v70, v10, 2, v9
  v_subrev_u32 v8, 1792, v2
  v_cvt_f32_u32 v8, v8
  v_cvt_pk_bf16_f32 v8, v8, v8
  v_lshlrev_b32 v8, 16, v8
  v_cvt_u32_f32 v8, v8
  v_lshrrev_b32 v9, 5, v8
  v_and_b32 v10, 31, v8
  v_mul_u32_u24 v9, 144, v9
  v_lshl_add_u32 v71, v10, 2, v9
  ds_write_b128 v1, v[192:195] offset:0
  ds_write_b128 v1, v[196:199] offset:64
  ds_write_b128 v1, v[200:203] offset:2304
  ds_write_b128 v1, v[204:207] offset:2368
  ds_write_b128 v1, v[208:211] offset:4608
  ds_write_b128 v1, v[212:215] offset:4672
  ds_write_b128 v1, v[216:219] offset:6912
  ds_write_b128 v1, v[220:223] offset:6976
  v_mov_b32 v72, 0
  s_waitcnt lgkmcnt(0)
  s_barrier
  ds_read_b32 v16, v64 offset:0
  ds_read_b32 v17, v64 offset:9360
  ds_read_b32 v18, v64 offset:18720
  ds_read_b32 v19, v64 offset:28080
  ds_read_b32 v20, v65 offset:0
  ds_read_b32 v21, v65 offset:9360
  ds_read_b32 v22, v65 offset:18720
  ds_read_b32 v23, v65 offset:28080
  ds_read_b32 v24, v66 offset:0
  ds_read_b32 v25, v66 offset:9360
  ds_read_b32 v26, v66 offset:18720
  ds_read_b32 v27, v66 offset:28080
  ds_read_b32 v28, v67 offset:0
  ds_read_b32 v29, v67 offset:9360
  ds_read_b32 v30, v67 offset:18720
  ds_read_b32 v31, v67 offset:28080
  ds_read_b32 v32, v68 offset:0
  ds_read_b32 v33, v68 offset:9360
  ds_read_b32 v34, v68 offset:18720
  ds_read_b32 v35, v68 offset:28080
  ds_read_b32 v36, v69 offset:0
  ds_read_b32 v37, v69 offset:9360
  ds_read_b32 v38, v69 offset:18720
  ds_read_b32 v39, v69 offset:28080
  ds_read_b32 v40, v70 offset:0
  ds_read_b32 v41, v70 offset:9360
  ds_read_b32 v42, v70 offset:18720
  ds_read_b32 v43, v70 offset:28080
  ds_read_b32 v44, v71 offset:0
  ds_read_b32 v45, v71 offset:9360
  ds_read_b32 v46, v71 offset:18720
  ds_read_b32 v47, v71 offset:28080
  ds_read_b32 v48, v72 offset:9220
  ds_read_b32 v49, v72 offset:18580
  ds_read_b32 v50, v72 offset:27940
  ds_read_b32 v51, v72 offset:37300
  v_lshlrev_b32 v3, 1, v7
  v_add_u32 v3, 48640, v3
  v_mov_b32 v56, 0
  v_mov_b32 v57, 0
  v_mov_b32 v58, 0
  v_mov_b32 v59, 0
  v_mov_b32 v4, 48640
  ds_write_b128 v4, v[56:59] offset:4096
  ds_write_b128 v4, v[56:59] offset:4112
  ds_write_b128 v4, v[56:59] offset:4128
  ds_write_b128 v4, v[56:59] offset:4144
  s_waitcnt lgkmcnt(4)
  v_add_f32 v48, v48, v49
  v_add_f32 v50, v50, v51
  v_add_f32 v48, v48, v50
  v_frexp_exp_i32_f32 v49, v48
  v_sub_u32 v50, 14, v49
  v_subrev_u32 v51, 14, v49
  v_ldexp_f32 v50, 1.0, v50
  v_ldexp_f32 v240, 1.0, v51
  v_add_f32 v16, v16, v17
  v_add_f32 v18, v18, v19
  v_add_f32 v16, v16, v18
  v_mul_f32 v16, v50, v16
  v_cvt_f16_f32 v16, v16
  ds_write_b16 v3, v16 offset:0
  v_add_f32 v20, v20, v21
  v_add_f32 v22, v22, v23
  v_add_f32 v20, v20, v22
  v_mul_f32 v20, v50, v20
  v_cvt_f16_f32 v20, v20
  ds_write_b16 v3, v20 offset:512
  v_add_f32 v24, v24, v25
  v_add_f32 v26, v26, v27
  v_add_f32 v24, v24, v26
  v_mul_f32 v24, v50, v24
  v_cvt_f16_f32 v24, v24
  ds_write_b16 v3, v24 offset:1024
  v_add_f32 v28, v28, v29
  v_add_f32 v30, v30, v31
  v_add_f32 v28, v28, v30
  v_mul_f32 v28, v50, v28
  v_cvt_f16_f32 v28, v28
  ds_write_b16 v3, v28 offset:1536
  v_add_f32 v32, v32, v33
  v_add_f32 v34, v34, v35
  v_add_f32 v32, v32, v34
  v_mul_f32 v32, v50, v32
  v_cvt_f16_f32 v32, v32
  ds_write_b16 v3, v32 offset:2048
  v_add_f32 v36, v36, v37
  v_add_f32 v38, v38, v39
  v_add_f32 v36, v36, v38
  v_mul_f32 v36, v50, v36
  v_cvt_f16_f32 v36, v36
  ds_write_b16 v3, v36 offset:2560
  v_add_f32 v40, v40, v41
  v_add_f32 v42, v42, v43
  v_add_f32 v40, v40, v42
  v_mul_f32 v40, v50, v40
  v_cvt_f16_f32 v40, v40
  ds_write_b16 v3, v40 offset:3072
  v_add_f32 v44, v44, v45
  v_add_f32 v46, v46, v47
  v_add_f32 v44, v44, v46
  v_mul_f32 v44, v50, v44
  v_cvt_f16_f32 v44, v44
  ds_write_b16 v3, v44 offset:3584
  s_waitcnt vmcnt(5)
  v_lshlrev_b32 v232, 16, v232
  v_lshlrev_b32 v233, 16, v233
  v_lshlrev_b32 v234, 16, v234
  v_lshlrev_b32 v235, 16, v235
  v_lshlrev_b32 v236, 16, v236
  v_lshlrev_b32 v237, 16, v237
  v_lshlrev_b32 v238, 16, v238
  v_lshlrev_b32 v239, 16, v239
  s_mov_b32 s74, 0x3fb8aa3b
  s_mov_b32 s75, 0x32a57060
  v_mul_f32 v15, s74, v238
  v_fma_f32 v16, v238, s74, -v15
  v_fma_f32 v16, v238, s75, v16
  v_exp_f32 v15, v15
  v_mul_f32 v16, 0x3f317218, v16
  v_fma_f32 v15, v15, v16, v15
  v_cvt_pk_bf16_f32 v15, v15, v15
  v_lshlrev_b32 v15, 16, v15
  v_mul_f32 v8, v15, v232
  v_mul_f32 v9, v15, v233
  v_mul_f32 v10, v15, v234
  v_mul_f32 v11, v15, v235
  v_pk_mul_f32 v[18:19], v[236:237], v[10:11] op_sel_hi:[1,0]
  v_pk_fma_f32 v[18:19], v[236:237], v[10:11], v[18:19] op_sel:[1,1,0] op_sel_hi:[0,1,1] neg_lo:[1,0,0]
  v_mul_f32 v16, s74, v8
  v_mul_f32 v17, 0x3e22f983, v9
  v_mul_f32 v30, 0x41800000, v16
  v_mul_f32 v32, 0x44000000, v16
  v_mul_f32 v34, 0x45000000, v16
  v_mul_f32 v31, 0x41800000, v17
  v_mul_f32 v33, 0x44000000, v17
  v_mul_f32 v35, 0x45000000, v17
  v_exp_f32 v30, v30
  v_exp_f32 v32, v32
  v_exp_f32 v34, v34
  v_fract_f32 v31, v31
  v_fract_f32 v33, v33
  v_fract_f32 v35, v35
  v_cos_f32 v20, v31
  v_cos_f32 v22, v33
  v_cos_f32 v24, v35
  v_sin_f32 v21, v31
  v_sin_f32 v23, v33
  v_sin_f32 v25, v35
  s_nop 0
  s_nop 0
  s_nop 0
  v_mul_f32 v20, v20, v30
  v_mul_f32 v22, v22, v32
  v_mul_f32 v24, v24, v34
  v_mul_f32 v21, v21, v30
  v_mul_f32 v23, v23, v32
  v_mul_f32 v25, v25, v34
  v_mul_f32 v26, v19, v25
  v_fma_f32 v26, v18, v24, -v26
  v_mul_f32 v27, 0x45000000, v16
  v_max_f32 v27, 0, v27
  v_exp_f32 v27, v27
  v_add_f32 v28, abs(v18), abs(v19)
  v_mul_f32 v27, v27, v28
  v_cmp_gt_u32 vcc, 32, v0
  s_nop 1
  v_cndmask_b32 v26, 0, v26, vcc
  v_cndmask_b32 v27, 0, v27, vcc
  s_nop 1
  v_add_f32_dpp v26, v26, v26 row_shr:1 row_mask:0xf bank_mask:0xf bound_ctrl:0
  s_nop 1
  v_add_f32_dpp v26, v26, v26 row_shr:2 row_mask:0xf bank_mask:0xf bound_ctrl:0
  s_nop 1
  v_add_f32_dpp v26, v26, v26 row_shr:4 row_mask:0xf bank_mask:0xf bound_ctrl:0
  s_nop 1
  v_add_f32_dpp v26, v26, v26 row_shr:8 row_mask:0xf bank_mask:0xf bound_ctrl:0
  s_nop 1
  v_add_f32_dpp v26, v26, v26 row_bcast:15 row_mask:0xa bank_mask:0xf
  s_nop 1
  v_add_f32_dpp v26, v26, v26 row_bcast:31 row_mask:0xc bank_mask:0xf
  s_nop 1
  s_nop 1
  v_add_f32_dpp v27, v27, v27 row_shr:1 row_mask:0xf bank_mask:0xf bound_ctrl:0
  s_nop 1
  v_add_f32_dpp v27, v27, v27 row_shr:2 row_mask:0xf bank_mask:0xf bound_ctrl:0
  s_nop 1
  v_add_f32_dpp v27, v27, v27 row_shr:4 row_mask:0xf bank_mask:0xf bound_ctrl:0
  s_nop 1
  v_add_f32_dpp v27, v27, v27 row_shr:8 row_mask:0xf bank_mask:0xf bound_ctrl:0
  s_nop 1
  v_add_f32_dpp v27, v27, v27 row_bcast:15 row_mask:0xa bank_mask:0xf
  s_nop 1
  v_add_f32_dpp v27, v27, v27 row_bcast:31 row_mask:0xc bank_mask:0xf
  s_nop 1
  s_barrier
  s_mul_i32 s78, s50, 9360
  s_add_u32 s78, s78, 0
  v_and_b32 v1, 31, v0
  v_lshlrev_b32 v1, 5, v1
  v_add_u32 v1, s78, v1
  ds_write_b128 v1, v[16:19]
  ds_write_b128 v1, v[20:23] offset:16
  v_readlane_b32 s76, v26, 63
  v_readlane_b32 s77, v27, 63
  s_nop 1
  v_mov_b32 v2, s76
  v_mov_b32 v3, s77
  v_mov_b32 v1, s78
  ds_write_b64 v1, v[2:3] offset:9216
  v_mov_b32 v192, 0
  v_mov_b32 v193, 0
  v_mov_b32 v194, 0
  v_mov_b32 v195, 0
  v_mov_b32 v196, 0
  v_mov_b32 v197, 0
  v_mov_b32 v198, 0
  v_mov_b32 v199, 0
  v_mov_b32 v200, 0
  v_mov_b32 v201, 0
  v_mov_b32 v202, 0
  v_mov_b32 v203, 0
  v_mov_b32 v204, 0
  v_mov_b32 v205, 0
  v_mov_b32 v206, 0
  v_mov_b32 v207, 0
  v_mov_b32 v208, 0
  v_mov_b32 v209, 0
  v_mov_b32 v210, 0
  v_mov_b32 v211, 0
  v_mov_b32 v212, 0
  v_mov_b32 v213, 0
  v_mov_b32 v214, 0
  v_mov_b32 v215, 0
  v_mov_b32 v216, 0
  v_mov_b32 v217, 0
  v_mov_b32 v218, 0
  v_mov_b32 v219, 0
  v_mov_b32 v220, 0
  v_mov_b32 v221, 0
  v_mov_b32 v222, 0
  v_mov_b32 v223, 0
  v_and_b32 v1, 15, v0
  v_cvt_f32_u32 v2, v1
  v_mul_f32 v4, 0x42000000, v2
  v_mov_b32 v3, v2
  v_mov_b32 v5, v4
  v_lshrrev_b32 v6, 4, v0
  v_lshlrev_b32 v6, 7, v6
  v_add_u32 v6, s78, v6
  s_waitcnt lgkmcnt(0)
  ds_read_b128 v[64:67], v6 offset:0
  ds_read_b128 v[68:71], v6 offset:16
  ds_read_b128 v[92:95], v6 offset:32
  ds_read_b128 v[96:99], v6 offset:48
  ds_read_b128 v[120:123], v6 offset:64
  ds_read_b128 v[124:127], v6 offset:80
  ds_read_b128 v[148:151], v6 offset:96
  ds_read_b128 v[152:155], v6 offset:112
  s_waitcnt lgkmcnt(0)
  v_pk_mul_f32 v[86:87], v[64:65], v[2:3]
  v_pk_mul_f32 v[114:115], v[92:93], v[2:3]
  v_pk_mul_f32 v[142:143], v[120:121], v[2:3]
  v_pk_mul_f32 v[170:171], v[148:149], v[2:3]
  v_pk_mul_f32 v[88:89], v[64:65], v[4:5]
  v_pk_mul_f32 v[116:117], v[92:93], v[4:5]
  v_pk_mul_f32 v[144:145], v[120:121], v[4:5]
  v_pk_mul_f32 v[172:173], v[148:149], v[4:5]
  v_exp_f32 v86, v86
  v_exp_f32 v114, v114
  v_exp_f32 v142, v142
  v_exp_f32 v170, v170
  v_exp_f32 v88, v88
  v_exp_f32 v116, v116
  v_exp_f32 v144, v144
  v_exp_f32 v172, v172
  v_fract_f32 v87, v87
  v_fract_f32 v115, v115
  v_fract_f32 v143, v143
  v_fract_f32 v171, v171
  v_fract_f32 v89, v89
  v_fract_f32 v117, v117
  v_fract_f32 v145, v145
  v_fract_f32 v173, v173
  v_cos_f32 v72, v87
  v_cos_f32 v100, v115
  v_cos_f32 v128, v143
  v_cos_f32 v156, v171
  v_sin_f32 v73, v87
  v_sin_f32 v101, v115
  v_sin_f32 v129, v143
  v_sin_f32 v157, v171
  v_cos_f32 v84, v89
  v_cos_f32 v112, v117
  v_cos_f32 v140, v145
  v_cos_f32 v168, v173
  v_sin_f32 v85, v89
  v_sin_f32 v113, v117
  v_sin_f32 v141, v145
  v_sin_f32 v169, v173
  s_nop 0
  s_nop 0
  s_nop 0
  s_nop 0
  v_pk_mul_f32 v[72:73], v[72:73], v[86:87] op_sel_hi:[1,0]
  v_pk_mul_f32 v[100:101], v[100:101], v[114:115] op_sel_hi:[1,0]
  v_pk_mul_f32 v[128:129], v[128:129], v[142:143] op_sel_hi:[1,0]
  v_pk_mul_f32 v[156:157], v[156:157], v[170:171] op_sel_hi:[1,0]
  v_pk_mul_f32 v[84:85], v[84:85], v[88:89] op_sel_hi:[1,0]
  v_pk_mul_f32 v[112:113], v[112:113], v[116:117] op_sel_hi:[1,0]
  v_pk_mul_f32 v[140:141], v[140:141], v[144:145] op_sel_hi:[1,0]
  v_pk_mul_f32 v[168:169], v[168:169], v[172:173] op_sel_hi:[1,0]
  v_pk_mul_f32 v[74:75], v[72:73], v[68:69] op_sel_hi:[1,0]
  v_pk_mul_f32 v[102:103], v[100:101], v[96:97] op_sel_hi:[1,0]
  v_pk_mul_f32 v[130:131], v[128:129], v[124:125] op_sel_hi:[1,0]
  v_pk_mul_f32 v[158:159], v[156:157], v[152:153] op_sel_hi:[1,0]
  v_pk_fma_f32 v[74:75], v[72:73], v[68:69], v[74:75] op_sel:[1,1,0] op_sel_hi:[0,1,1] neg_lo:[1,0,0]
  v_pk_fma_f32 v[102:103], v[100:101], v[96:97], v[102:103] op_sel:[1,1,0] op_sel_hi:[0,1,1] neg_lo:[1,0,0]
  v_pk_fma_f32 v[130:131], v[128:129], v[124:125], v[130:131] op_sel:[1,1,0] op_sel_hi:[0,1,1] neg_lo:[1,0,0]
  v_pk_fma_f32 v[158:159], v[156:157], v[152:153], v[158:159] op_sel:[1,1,0] op_sel_hi:[0,1,1] neg_lo:[1,0,0]
  v_pk_mul_f32 v[76:77], v[84:85], v[66:67] op_sel_hi:[1,0]
  v_pk_mul_f32 v[104:105], v[112:113], v[94:95] op_sel_hi:[1,0]
  v_pk_mul_f32 v[132:133], v[140:141], v[122:123] op_sel_hi:[1,0]
  v_pk_mul_f32 v[160:161], v[168:169], v[150:151] op_sel_hi:[1,0]
  v_pk_fma_f32 v[76:77], v[84:85], v[66:67], v[76:77] op_sel:[1,1,0] op_sel_hi:[0,1,1] neg_lo:[1,0,0]
  v_pk_fma_f32 v[104:105], v[112:113], v[94:95], v[104:105] op_sel:[1,1,0] op_sel_hi:[0,1,1] neg_lo:[1,0,0]
  v_pk_fma_f32 v[132:133], v[140:141], v[122:123], v[132:133] op_sel:[1,1,0] op_sel_hi:[0,1,1] neg_lo:[1,0,0]
  v_pk_fma_f32 v[160:161], v[168:169], v[150:151], v[160:161] op_sel:[1,1,0] op_sel_hi:[0,1,1] neg_lo:[1,0,0]
  v_pk_mul_f32 v[78:79], v[76:77], v[70:71] op_sel_hi:[1,0]
  v_pk_mul_f32 v[106:107], v[104:105], v[98:99] op_sel_hi:[1,0]
  v_pk_mul_f32 v[134:135], v[132:133], v[126:127] op_sel_hi:[1,0]
  v_pk_mul_f32 v[162:163], v[160:161], v[154:155] op_sel_hi:[1,0]
  v_pk_fma_f32 v[78:79], v[76:77], v[70:71], v[78:79] op_sel:[1,1,0] op_sel_hi:[0,1,1] neg_lo:[1,0,0]
  v_pk_fma_f32 v[106:107], v[104:105], v[98:99], v[106:107] op_sel:[1,1,0] op_sel_hi:[0,1,1] neg_lo:[1,0,0]
  v_pk_fma_f32 v[134:135], v[132:133], v[126:127], v[134:135] op_sel:[1,1,0] op_sel_hi:[0,1,1] neg_lo:[1,0,0]
  v_pk_fma_f32 v[162:163], v[160:161], v[154:155], v[162:163] op_sel:[1,1,0] op_sel_hi:[0,1,1] neg_lo:[1,0,0]
  v_pk_mul_f32 v[80:81], v[78:79], v[70:71] op_sel_hi:[1,0]
  v_pk_mul_f32 v[108:109], v[106:107], v[98:99] op_sel_hi:[1,0]
  v_pk_mul_f32 v[136:137], v[134:135], v[126:127] op_sel_hi:[1,0]
  v_pk_mul_f32 v[164:165], v[162:163], v[154:155] op_sel_hi:[1,0]
  v_pk_fma_f32 v[80:81], v[78:79], v[70:71], v[80:81] op_sel:[1,1,0] op_sel_hi:[0,1,1] neg_lo:[1,0,0]
  v_pk_fma_f32 v[108:109], v[106:107], v[98:99], v[108:109] op_sel:[1,1,0] op_sel_hi:[0,1,1] neg_lo:[1,0,0]
  v_pk_fma_f32 v[136:137], v[134:135], v[126:127], v[136:137] op_sel:[1,1,0] op_sel_hi:[0,1,1] neg_lo:[1,0,0]
  v_pk_fma_f32 v[164:165], v[162:163], v[154:155], v[164:165] op_sel:[1,1,0] op_sel_hi:[0,1,1] neg_lo:[1,0,0]
  v_pk_mul_f32 v[82:83], v[80:81], v[70:71] op_sel_hi:[1,0]
  v_pk_mul_f32 v[110:111], v[108:109], v[98:99] op_sel_hi:[1,0]
  v_pk_mul_f32 v[138:139], v[136:137], v[126:127] op_sel_hi:[1,0]
  v_pk_mul_f32 v[166:167], v[164:165], v[154:155] op_sel_hi:[1,0]
  v_pk_fma_f32 v[82:83], v[80:81], v[70:71], v[82:83] op_sel:[1,1,0] op_sel_hi:[0,1,1] neg_lo:[1,0,0]
  v_pk_fma_f32 v[110:111], v[108:109], v[98:99], v[110:111] op_sel:[1,1,0] op_sel_hi:[0,1,1] neg_lo:[1,0,0]
  v_pk_fma_f32 v[138:139], v[136:137], v[126:127], v[138:139] op_sel:[1,1,0] op_sel_hi:[0,1,1] neg_lo:[1,0,0]
  v_pk_fma_f32 v[166:167], v[164:165], v[154:155], v[166:167] op_sel:[1,1,0] op_sel_hi:[0,1,1] neg_lo:[1,0,0]
  v_cvt_pk_bf16_f32 v16, v72, -v73
  v_cvt_pk_bf16_f32 v17, v100, -v101
  v_cvt_pk_bf16_f32 v18, v128, -v129
  v_cvt_pk_bf16_f32 v19, v156, -v157
  v_lshlrev_b32 v86, 16, v16
  v_lshlrev_b32 v114, 16, v17
  v_lshlrev_b32 v142, 16, v18
  v_lshlrev_b32 v170, 16, v19
  v_and_b32 v87, 0xffff0000, v16
  v_and_b32 v115, 0xffff0000, v17
  v_and_b32 v143, 0xffff0000, v18
  v_and_b32 v171, 0xffff0000, v19
  v_pk_add_f32 v[86:87], v[72:73], v[86:87] neg_lo:[0,1] neg_hi:[1,1]
  v_pk_add_f32 v[114:115], v[100:101], v[114:115] neg_lo:[0,1] neg_hi:[1,1]
  v_pk_add_f32 v[142:143], v[128:129], v[142:143] neg_lo:[0,1] neg_hi:[1,1]
  v_pk_add_f32 v[170:171], v[156:157], v[170:171] neg_lo:[0,1] neg_hi:[1,1]
  v_cvt_pk_bf16_f32 v20, v86, v87
  v_cvt_pk_bf16_f32 v21, v114, v115
  v_cvt_pk_bf16_f32 v22, v142, v143
  v_cvt_pk_bf16_f32 v23, v170, v171
  v_cvt_pk_bf16_f32 v24, v74, -v75
  v_cvt_pk_bf16_f32 v25, v102, -v103
  v_cvt_pk_bf16_f32 v26, v130, -v131
  v_cvt_pk_bf16_f32 v27, v158, -v159
  v_lshlrev_b32 v88, 16, v24
  v_lshlrev_b32 v116, 16, v25
  v_lshlrev_b32 v144, 16, v26
  v_lshlrev_b32 v172, 16, v27
  v_and_b32 v89, 0xffff0000, v24
  v_and_b32 v117, 0xffff0000, v25
  v_and_b32 v145, 0xffff0000, v26
  v_and_b32 v173, 0xffff0000, v27
  v_pk_add_f32 v[88:89], v[74:75], v[88:89] neg_lo:[0,1] neg_hi:[1,1]
  v_pk_add_f32 v[116:117], v[102:103], v[116:117] neg_lo:[0,1] neg_hi:[1,1]
  v_pk_add_f32 v[144:145], v[130:131], v[144:145] neg_lo:[0,1] neg_hi:[1,1]
  v_pk_add_f32 v[172:173], v[158:159], v[172:173] neg_lo:[0,1] neg_hi:[1,1]
  v_cvt_pk_bf16_f32 v28, v88, v89
  v_cvt_pk_bf16_f32 v29, v116, v117
  v_cvt_pk_bf16_f32 v30, v144, v145
  v_cvt_pk_bf16_f32 v31, v172, v173
  v_cvt_pk_bf16_f32 v32, v76, v77
  v_cvt_pk_bf16_f32 v33, v104, v105
  v_cvt_pk_bf16_f32 v34, v132, v133
  v_cvt_pk_bf16_f32 v35, v160, v161
  v_lshlrev_b32 v90, 16, v32
  v_lshlrev_b32 v118, 16, v33
  v_lshlrev_b32 v146, 16, v34
  v_lshlrev_b32 v174, 16, v35
  v_and_b32 v91, 0xffff0000, v32
  v_and_b32 v119, 0xffff0000, v33
  v_and_b32 v147, 0xffff0000, v34
  v_and_b32 v175, 0xffff0000, v35
  v_pk_add_f32 v[90:91], v[76:77], v[90:91] neg_lo:[0,1] neg_hi:[0,1]
  v_pk_add_f32 v[118:119], v[104:105], v[118:119] neg_lo:[0,1] neg_hi:[0,1]
  v_pk_add_f32 v[146:147], v[132:133], v[146:147] neg_lo:[0,1] neg_hi:[0,1]
  v_pk_add_f32 v[174:175], v[160:161], v[174:175] neg_lo:[0,1] neg_hi:[0,1]
  v_cvt_pk_bf16_f32 v36, v90, v91
  v_cvt_pk_bf16_f32 v37, v118, v119
  v_cvt_pk_bf16_f32 v38, v146, v147
  v_cvt_pk_bf16_f32 v39, v174, v175
  v_cvt_pk_bf16_f32 v40, v78, v79
  v_cvt_pk_bf16_f32 v41, v106, v107
  v_cvt_pk_bf16_f32 v42, v134, v135
  v_cvt_pk_bf16_f32 v43, v162, v163
  v_lshlrev_b32 v86, 16, v40
  v_lshlrev_b32 v114, 16, v41
  v_lshlrev_b32 v142, 16, v42
  v_lshlrev_b32 v170, 16, v43
  v_and_b32 v87, 0xffff0000, v40
  v_and_b32 v115, 0xffff0000, v41
  v_and_b32 v143, 0xffff0000, v42
  v_and_b32 v171, 0xffff0000, v43
  v_pk_add_f32 v[86:87], v[78:79], v[86:87] neg_lo:[0,1] neg_hi:[0,1]
  v_pk_add_f32 v[114:115], v[106:107], v[114:115] neg_lo:[0,1] neg_hi:[0,1]
  v_pk_add_f32 v[142:143], v[134:135], v[142:143] neg_lo:[0,1] neg_hi:[0,1]
  v_pk_add_f32 v[170:171], v[162:163], v[170:171] neg_lo:[0,1] neg_hi:[0,1]
  v_cvt_pk_bf16_f32 v44, v86, v87
  v_cvt_pk_bf16_f32 v45, v114, v115
  v_cvt_pk_bf16_f32 v46, v142, v143
  v_cvt_pk_bf16_f32 v47, v170, v171
  v_cvt_pk_bf16_f32 v48, v80, v81
  v_cvt_pk_bf16_f32 v49, v108, v109
  v_cvt_pk_bf16_f32 v50, v136, v137
  v_cvt_pk_bf16_f32 v51, v164, v165
  v_lshlrev_b32 v88, 16, v48
  v_lshlrev_b32 v116, 16, v49
  v_lshlrev_b32 v144, 16, v50
  v_lshlrev_b32 v172, 16, v51
  v_and_b32 v89, 0xffff0000, v48
  v_and_b32 v117, 0xffff0000, v49
  v_and_b32 v145, 0xffff0000, v50
  v_and_b32 v173, 0xffff0000, v51
  v_pk_add_f32 v[88:89], v[80:81], v[88:89] neg_lo:[0,1] neg_hi:[0,1]
  v_pk_add_f32 v[116:117], v[108:109], v[116:117] neg_lo:[0,1] neg_hi:[0,1]
  v_pk_add_f32 v[144:145], v[136:137], v[144:145] neg_lo:[0,1] neg_hi:[0,1]
  v_pk_add_f32 v[172:173], v[164:165], v[172:173] neg_lo:[0,1] neg_hi:[0,1]
  v_cvt_pk_bf16_f32 v52, v88, v89
  v_cvt_pk_bf16_f32 v53, v116, v117
  v_cvt_pk_bf16_f32 v54, v144, v145
  v_cvt_pk_bf16_f32 v55, v172, v173
  v_cvt_pk_bf16_f32 v56, v82, v83
  v_cvt_pk_bf16_f32 v57, v110, v111
  v_cvt_pk_bf16_f32 v58, v138, v139
  v_cvt_pk_bf16_f32 v59, v166, v167
  v_lshlrev_b32 v90, 16, v56
  v_lshlrev_b32 v118, 16, v57
  v_lshlrev_b32 v146, 16, v58
  v_lshlrev_b32 v174, 16, v59
  v_and_b32 v91, 0xffff0000, v56
  v_and_b32 v119, 0xffff0000, v57
  v_and_b32 v147, 0xffff0000, v58
  v_and_b32 v175, 0xffff0000, v59
  v_pk_add_f32 v[90:91], v[82:83], v[90:91] neg_lo:[0,1] neg_hi:[0,1]
  v_pk_add_f32 v[118:119], v[110:111], v[118:119] neg_lo:[0,1] neg_hi:[0,1]
  v_pk_add_f32 v[146:147], v[138:139], v[146:147] neg_lo:[0,1] neg_hi:[0,1]
  v_pk_add_f32 v[174:175], v[166:167], v[174:175] neg_lo:[0,1] neg_hi:[0,1]
  v_cvt_pk_bf16_f32 v60, v90, v91
  v_cvt_pk_bf16_f32 v61, v118, v119
  v_cvt_pk_bf16_f32 v62, v146, v147
  v_cvt_pk_bf16_f32 v63, v174, v175
  s_nop 1
  v_mfma_f32_16x16x32_bf16 v[192:195], v[16:19], v[32:35], v[192:195]
  v_mfma_f32_16x16x32_bf16 v[196:199], v[24:27], v[32:35], v[196:199]
  v_mfma_f32_16x16x32_bf16 v[200:203], v[16:19], v[40:43], v[200:203]
  v_mfma_f32_16x16x32_bf16 v[204:207], v[24:27], v[40:43], v[204:207]
  v_mfma_f32_16x16x32_bf16 v[208:211], v[16:19], v[48:51], v[208:211]
  v_mfma_f32_16x16x32_bf16 v[212:215], v[24:27], v[48:51], v[212:215]
  v_mfma_f32_16x16x32_bf16 v[216:219], v[16:19], v[56:59], v[216:219]
  v_mfma_f32_16x16x32_bf16 v[220:223], v[24:27], v[56:59], v[220:223]
  v_mfma_f32_16x16x32_bf16 v[192:195], v[20:23], v[32:35], v[192:195]
  v_mfma_f32_16x16x32_bf16 v[196:199], v[28:31], v[32:35], v[196:199]
  v_mfma_f32_16x16x32_bf16 v[200:203], v[20:23], v[40:43], v[200:203]
  v_mfma_f32_16x16x32_bf16 v[204:207], v[28:31], v[40:43], v[204:207]
  v_mfma_f32_16x16x32_bf16 v[208:211], v[20:23], v[48:51], v[208:211]
  v_mfma_f32_16x16x32_bf16 v[212:215], v[28:31], v[48:51], v[212:215]
  v_mfma_f32_16x16x32_bf16 v[216:219], v[20:23], v[56:59], v[216:219]
  v_mfma_f32_16x16x32_bf16 v[220:223], v[28:31], v[56:59], v[220:223]
  v_mfma_f32_16x16x32_bf16 v[192:195], v[16:19], v[36:39], v[192:195]
  v_mfma_f32_16x16x32_bf16 v[196:199], v[24:27], v[36:39], v[196:199]
  v_mfma_f32_16x16x32_bf16 v[200:203], v[16:19], v[44:47], v[200:203]
  v_mfma_f32_16x16x32_bf16 v[204:207], v[24:27], v[44:47], v[204:207]
  v_mfma_f32_16x16x32_bf16 v[208:211], v[16:19], v[52:55], v[208:211]
  v_mfma_f32_16x16x32_bf16 v[212:215], v[24:27], v[52:55], v[212:215]
  v_mfma_f32_16x16x32_bf16 v[216:219], v[16:19], v[60:63], v[216:219]
  v_mfma_f32_16x16x32_bf16 v[220:223], v[24:27], v[60:63], v[220:223]
  s_and_b32 s6, s5, 7
  s_mul_i32 s6, s6, 224
  s_mul_i32 s7, s50, 56
  s_add_u32 s6, s6, s7
  v_min_u32 v180, 55, v0
  v_add_u32 v180, s6, v180
  v_lshlrev_b32 v180, 10, v180
  s_and_b32 s6, s4, 1
  s_lshl_b32 s6, s6, 2
  s_lshr_b32 s7, s5, 3
  s_add_u32 s6, s6, s7
  s_lshl_b32 s6, s6, 7
  v_add_u32 v180, s6, v180
  global_load_dword v243, v180, s[40:41]
  ds_read_b128 v[64:67], v6 offset:512
  ds_read_b128 v[68:71], v6 offset:528
  ds_read_b128 v[92:95], v6 offset:544
  ds_read_b128 v[96:99], v6 offset:560
  ds_read_b128 v[120:123], v6 offset:576
  ds_read_b128 v[124:127], v6 offset:592
  ds_read_b128 v[148:151], v6 offset:608
  ds_read_b128 v[152:155], v6 offset:624
  s_waitcnt lgkmcnt(0)
  v_pk_mul_f32 v[86:87], v[64:65], v[2:3]
  v_pk_mul_f32 v[114:115], v[92:93], v[2:3]
  v_pk_mul_f32 v[142:143], v[120:121], v[2:3]
  v_pk_mul_f32 v[170:171], v[148:149], v[2:3]
  v_pk_mul_f32 v[88:89], v[64:65], v[4:5]
  v_pk_mul_f32 v[116:117], v[92:93], v[4:5]
  v_pk_mul_f32 v[144:145], v[120:121], v[4:5]
  v_pk_mul_f32 v[172:173], v[148:149], v[4:5]
  v_exp_f32 v86, v86
  v_exp_f32 v114, v114
  v_exp_f32 v142, v142
  v_exp_f32 v170, v170
  v_exp_f32 v88, v88
  v_exp_f32 v116, v116
  v_exp_f32 v144, v144
  v_exp_f32 v172, v172
  v_fract_f32 v87, v87
  v_fract_f32 v115, v115
  v_fract_f32 v143, v143
  v_fract_f32 v171, v171
  v_fract_f32 v89, v89
  v_fract_f32 v117, v117
  v_fract_f32 v145, v145
  v_fract_f32 v173, v173
  v_cos_f32 v72, v87
  v_cos_f32 v100, v115
  v_cos_f32 v128, v143
  v_cos_f32 v156, v171
  v_sin_f32 v73, v87
  v_sin_f32 v101, v115
  v_sin_f32 v129, v143
  v_sin_f32 v157, v171
  v_cos_f32 v84, v89
  v_cos_f32 v112, v117
  v_cos_f32 v140, v145
  v_cos_f32 v168, v173
  v_sin_f32 v85, v89
  v_sin_f32 v113, v117
  v_sin_f32 v141, v145
  v_sin_f32 v169, v173
  s_nop 0
  s_nop 0
  s_nop 0
  s_nop 0
  v_pk_mul_f32 v[72:73], v[72:73], v[86:87] op_sel_hi:[1,0]
  v_pk_mul_f32 v[100:101], v[100:101], v[114:115] op_sel_hi:[1,0]
  v_pk_mul_f32 v[128:129], v[128:129], v[142:143] op_sel_hi:[1,0]
  v_pk_mul_f32 v[156:157], v[156:157], v[170:171] op_sel_hi:[1,0]
  v_pk_mul_f32 v[84:85], v[84:85], v[88:89] op_sel_hi:[1,0]
  v_pk_mul_f32 v[112:113], v[112:113], v[116:117] op_sel_hi:[1,0]
  v_pk_mul_f32 v[140:141], v[140:141], v[144:145] op_sel_hi:[1,0]
  v_pk_mul_f32 v[168:169], v[168:169], v[172:173] op_sel_hi:[1,0]
  v_pk_mul_f32 v[74:75], v[72:73], v[68:69] op_sel_hi:[1,0]
  v_pk_mul_f32 v[102:103], v[100:101], v[96:97] op_sel_hi:[1,0]
  v_pk_mul_f32 v[130:131], v[128:129], v[124:125] op_sel_hi:[1,0]
  v_pk_mul_f32 v[158:159], v[156:157], v[152:153] op_sel_hi:[1,0]
  v_pk_fma_f32 v[74:75], v[72:73], v[68:69], v[74:75] op_sel:[1,1,0] op_sel_hi:[0,1,1] neg_lo:[1,0,0]
  v_pk_fma_f32 v[102:103], v[100:101], v[96:97], v[102:103] op_sel:[1,1,0] op_sel_hi:[0,1,1] neg_lo:[1,0,0]
  v_pk_fma_f32 v[130:131], v[128:129], v[124:125], v[130:131] op_sel:[1,1,0] op_sel_hi:[0,1,1] neg_lo:[1,0,0]
  v_pk_fma_f32 v[158:159], v[156:157], v[152:153], v[158:159] op_sel:[1,1,0] op_sel_hi:[0,1,1] neg_lo:[1,0,0]
  v_pk_mul_f32 v[76:77], v[84:85], v[66:67] op_sel_hi:[1,0]
  v_pk_mul_f32 v[104:105], v[112:113], v[94:95] op_sel_hi:[1,0]
  v_pk_mul_f32 v[132:133], v[140:141], v[122:123] op_sel_hi:[1,0]
  v_pk_mul_f32 v[160:161], v[168:169], v[150:151] op_sel_hi:[1,0]
  v_pk_fma_f32 v[76:77], v[84:85], v[66:67], v[76:77] op_sel:[1,1,0] op_sel_hi:[0,1,1] neg_lo:[1,0,0]
  v_pk_fma_f32 v[104:105], v[112:113], v[94:95], v[104:105] op_sel:[1,1,0] op_sel_hi:[0,1,1] neg_lo:[1,0,0]
  v_pk_fma_f32 v[132:133], v[140:141], v[122:123], v[132:133] op_sel:[1,1,0] op_sel_hi:[0,1,1] neg_lo:[1,0,0]
  v_pk_fma_f32 v[160:161], v[168:169], v[150:151], v[160:161] op_sel:[1,1,0] op_sel_hi:[0,1,1] neg_lo:[1,0,0]
  v_pk_mul_f32 v[78:79], v[76:77], v[70:71] op_sel_hi:[1,0]
  v_pk_mul_f32 v[106:107], v[104:105], v[98:99] op_sel_hi:[1,0]
  v_pk_mul_f32 v[134:135], v[132:133], v[126:127] op_sel_hi:[1,0]
  v_pk_mul_f32 v[162:163], v[160:161], v[154:155] op_sel_hi:[1,0]
  v_pk_fma_f32 v[78:79], v[76:77], v[70:71], v[78:79] op_sel:[1,1,0] op_sel_hi:[0,1,1] neg_lo:[1,0,0]
  v_pk_fma_f32 v[106:107], v[104:105], v[98:99], v[106:107] op_sel:[1,1,0] op_sel_hi:[0,1,1] neg_lo:[1,0,0]
  v_pk_fma_f32 v[134:135], v[132:133], v[126:127], v[134:135] op_sel:[1,1,0] op_sel_hi:[0,1,1] neg_lo:[1,0,0]
  v_pk_fma_f32 v[162:163], v[160:161], v[154:155], v[162:163] op_sel:[1,1,0] op_sel_hi:[0,1,1] neg_lo:[1,0,0]
  v_pk_mul_f32 v[80:81], v[78:79], v[70:71] op_sel_hi:[1,0]
  v_pk_mul_f32 v[108:109], v[106:107], v[98:99] op_sel_hi:[1,0]
  v_pk_mul_f32 v[136:137], v[134:135], v[126:127] op_sel_hi:[1,0]
  v_pk_mul_f32 v[164:165], v[162:163], v[154:155] op_sel_hi:[1,0]
  v_pk_fma_f32 v[80:81], v[78:79], v[70:71], v[80:81] op_sel:[1,1,0] op_sel_hi:[0,1,1] neg_lo:[1,0,0]
  v_pk_fma_f32 v[108:109], v[106:107], v[98:99], v[108:109] op_sel:[1,1,0] op_sel_hi:[0,1,1] neg_lo:[1,0,0]
  v_pk_fma_f32 v[136:137], v[134:135], v[126:127], v[136:137] op_sel:[1,1,0] op_sel_hi:[0,1,1] neg_lo:[1,0,0]
  v_pk_fma_f32 v[164:165], v[162:163], v[154:155], v[164:165] op_sel:[1,1,0] op_sel_hi:[0,1,1] neg_lo:[1,0,0]
  v_pk_mul_f32 v[82:83], v[80:81], v[70:71] op_sel_hi:[1,0]
  v_pk_mul_f32 v[110:111], v[108:109], v[98:99] op_sel_hi:[1,0]
  v_pk_mul_f32 v[138:139], v[136:137], v[126:127] op_sel_hi:[1,0]
  v_pk_mul_f32 v[166:167], v[164:165], v[154:155] op_sel_hi:[1,0]
  v_pk_fma_f32 v[82:83], v[80:81], v[70:71], v[82:83] op_sel:[1,1,0] op_sel_hi:[0,1,1] neg_lo:[1,0,0]
  v_pk_fma_f32 v[110:111], v[108:109], v[98:99], v[110:111] op_sel:[1,1,0] op_sel_hi:[0,1,1] neg_lo:[1,0,0]
  v_pk_fma_f32 v[138:139], v[136:137], v[126:127], v[138:139] op_sel:[1,1,0] op_sel_hi:[0,1,1] neg_lo:[1,0,0]
  v_pk_fma_f32 v[166:167], v[164:165], v[154:155], v[166:167] op_sel:[1,1,0] op_sel_hi:[0,1,1] neg_lo:[1,0,0]
  v_cvt_pk_bf16_f32 v16, v72, -v73
  v_cvt_pk_bf16_f32 v17, v100, -v101
  v_cvt_pk_bf16_f32 v18, v128, -v129
  v_cvt_pk_bf16_f32 v19, v156, -v157
  v_lshlrev_b32 v86, 16, v16
  v_lshlrev_b32 v114, 16, v17
  v_lshlrev_b32 v142, 16, v18
  v_lshlrev_b32 v170, 16, v19
  v_and_b32 v87, 0xffff0000, v16
  v_and_b32 v115, 0xffff0000, v17
  v_and_b32 v143, 0xffff0000, v18
  v_and_b32 v171, 0xffff0000, v19
  v_pk_add_f32 v[86:87], v[72:73], v[86:87] neg_lo:[0,1] neg_hi:[1,1]
  v_pk_add_f32 v[114:115], v[100:101], v[114:115] neg_lo:[0,1] neg_hi:[1,1]
  v_pk_add_f32 v[142:143], v[128:129], v[142:143] neg_lo:[0,1] neg_hi:[1,1]
  v_pk_add_f32 v[170:171], v[156:157], v[170:171] neg_lo:[0,1] neg_hi:[1,1]
  v_cvt_pk_bf16_f32 v20, v86, v87
  v_cvt_pk_bf16_f32 v21, v114, v115
  v_cvt_pk_bf16_f32 v22, v142, v143
  v_cvt_pk_bf16_f32 v23, v170, v171
  v_cvt_pk_bf16_f32 v24, v74, -v75
  v_cvt_pk_bf16_f32 v25, v102, -v103
  v_cvt_pk_bf16_f32 v26, v130, -v131
  v_cvt_pk_bf16_f32 v27, v158, -v159
  v_lshlrev_b32 v88, 16, v24
  v_lshlrev_b32 v116, 16, v25
  v_lshlrev_b32 v144, 16, v26
  v_lshlrev_b32 v172, 16, v27
  v_and_b32 v89, 0xffff0000, v24
  v_and_b32 v117, 0xffff0000, v25
  v_and_b32 v145, 0xffff0000, v26
  v_and_b32 v173, 0xffff0000, v27
  v_pk_add_f32 v[88:89], v[74:75], v[88:89] neg_lo:[0,1] neg_hi:[1,1]
  v_pk_add_f32 v[116:117], v[102:103], v[116:117] neg_lo:[0,1] neg_hi:[1,1]
  v_pk_add_f32 v[144:145], v[130:131], v[144:145] neg_lo:[0,1] neg_hi:[1,1]
  v_pk_add_f32 v[172:173], v[158:159], v[172:173] neg_lo:[0,1] neg_hi:[1,1]
  v_cvt_pk_bf16_f32 v28, v88, v89
  v_cvt_pk_bf16_f32 v29, v116, v117
  v_cvt_pk_bf16_f32 v30, v144, v145
  v_cvt_pk_bf16_f32 v31, v172, v173
  v_cvt_pk_bf16_f32 v32, v76, v77
  v_cvt_pk_bf16_f32 v33, v104, v105
  v_cvt_pk_bf16_f32 v34, v132, v133
  v_cvt_pk_bf16_f32 v35, v160, v161
  v_lshlrev_b32 v90, 16, v32
  v_lshlrev_b32 v118, 16, v33
  v_lshlrev_b32 v146, 16, v34
  v_lshlrev_b32 v174, 16, v35
  v_and_b32 v91, 0xffff0000, v32
  v_and_b32 v119, 0xffff0000, v33
  v_and_b32 v147, 0xffff0000, v34
  v_and_b32 v175, 0xffff0000, v35
  v_pk_add_f32 v[90:91], v[76:77], v[90:91] neg_lo:[0,1] neg_hi:[0,1]
  v_pk_add_f32 v[118:119], v[104:105], v[118:119] neg_lo:[0,1] neg_hi:[0,1]
  v_pk_add_f32 v[146:147], v[132:133], v[146:147] neg_lo:[0,1] neg_hi:[0,1]
  v_pk_add_f32 v[174:175], v[160:161], v[174:175] neg_lo:[0,1] neg_hi:[0,1]
  v_cvt_pk_bf16_f32 v36, v90, v91
  v_cvt_pk_bf16_f32 v37, v118, v119
  v_cvt_pk_bf16_f32 v38, v146, v147
  v_cvt_pk_bf16_f32 v39, v174, v175
  v_cvt_pk_bf16_f32 v40, v78, v79
  v_cvt_pk_bf16_f32 v41, v106, v107
  v_cvt_pk_bf16_f32 v42, v134, v135
  v_cvt_pk_bf16_f32 v43, v162, v163
  v_lshlrev_b32 v86, 16, v40
  v_lshlrev_b32 v114, 16, v41
  v_lshlrev_b32 v142, 16, v42
  v_lshlrev_b32 v170, 16, v43
  v_and_b32 v87, 0xffff0000, v40
  v_and_b32 v115, 0xffff0000, v41
  v_and_b32 v143, 0xffff0000, v42
  v_and_b32 v171, 0xffff0000, v43
  v_pk_add_f32 v[86:87], v[78:79], v[86:87] neg_lo:[0,1] neg_hi:[0,1]
  v_pk_add_f32 v[114:115], v[106:107], v[114:115] neg_lo:[0,1] neg_hi:[0,1]
  v_pk_add_f32 v[142:143], v[134:135], v[142:143] neg_lo:[0,1] neg_hi:[0,1]
  v_pk_add_f32 v[170:171], v[162:163], v[170:171] neg_lo:[0,1] neg_hi:[0,1]
  v_cvt_pk_bf16_f32 v44, v86, v87
  v_cvt_pk_bf16_f32 v45, v114, v115
  v_cvt_pk_bf16_f32 v46, v142, v143
  v_cvt_pk_bf16_f32 v47, v170, v171
  v_cvt_pk_bf16_f32 v48, v80, v81
  v_cvt_pk_bf16_f32 v49, v108, v109
  v_cvt_pk_bf16_f32 v50, v136, v137
  v_cvt_pk_bf16_f32 v51, v164, v165
  v_lshlrev_b32 v88, 16, v48
  v_lshlrev_b32 v116, 16, v49
  v_lshlrev_b32 v144, 16, v50
  v_lshlrev_b32 v172, 16, v51
  v_and_b32 v89, 0xffff0000, v48
  v_and_b32 v117, 0xffff0000, v49
  v_and_b32 v145, 0xffff0000, v50
  v_and_b32 v173, 0xffff0000, v51
  v_pk_add_f32 v[88:89], v[80:81], v[88:89] neg_lo:[0,1] neg_hi:[0,1]
  v_pk_add_f32 v[116:117], v[108:109], v[116:117] neg_lo:[0,1] neg_hi:[0,1]
  v_pk_add_f32 v[144:145], v[136:137], v[144:145] neg_lo:[0,1] neg_hi:[0,1]
  v_pk_add_f32 v[172:173], v[164:165], v[172:173] neg_lo:[0,1] neg_hi:[0,1]
  v_cvt_pk_bf16_f32 v52, v88, v89
  v_cvt_pk_bf16_f32 v53, v116, v117
  v_cvt_pk_bf16_f32 v54, v144, v145
  v_cvt_pk_bf16_f32 v55, v172, v173
  v_cvt_pk_bf16_f32 v56, v82, v83
  v_cvt_pk_bf16_f32 v57, v110, v111
  v_cvt_pk_bf16_f32 v58, v138, v139
  v_cvt_pk_bf16_f32 v59, v166, v167
  v_lshlrev_b32 v90, 16, v56
  v_lshlrev_b32 v118, 16, v57
  v_lshlrev_b32 v146, 16, v58
  v_lshlrev_b32 v174, 16, v59
  v_and_b32 v91, 0xffff0000, v56
  v_and_b32 v119, 0xffff0000, v57
  v_and_b32 v147, 0xffff0000, v58
  v_and_b32 v175, 0xffff0000, v59
  v_pk_add_f32 v[90:91], v[82:83], v[90:91] neg_lo:[0,1] neg_hi:[0,1]
  v_pk_add_f32 v[118:119], v[110:111], v[118:119] neg_lo:[0,1] neg_hi:[0,1]
  v_pk_add_f32 v[146:147], v[138:139], v[146:147] neg_lo:[0,1] neg_hi:[0,1]
  v_pk_add_f32 v[174:175], v[166:167], v[174:175] neg_lo:[0,1] neg_hi:[0,1]
  v_cvt_pk_bf16_f32 v60, v90, v91
  v_cvt_pk_bf16_f32 v61, v118, v119
  v_cvt_pk_bf16_f32 v62, v146, v147
  v_cvt_pk_bf16_f32 v63, v174, v175
  s_nop 1
  v_mfma_f32_16x16x32_bf16 v[192:195], v[16:19], v[32:35], v[192:195]
  v_mfma_f32_16x16x32_bf16 v[196:199], v[24:27], v[32:35], v[196:199]
  v_mfma_f32_16x16x32_bf16 v[200:203], v[16:19], v[40:43], v[200:203]
  v_mfma_f32_16x16x32_bf16 v[204:207], v[24:27], v[40:43], v[204:207]
  v_mfma_f32_16x16x32_bf16 v[208:211], v[16:19], v[48:51], v[208:211]
  v_mfma_f32_16x16x32_bf16 v[212:215], v[24:27], v[48:51], v[212:215]
  v_mfma_f32_16x16x32_bf16 v[216:219], v[16:19], v[56:59], v[216:219]
  v_mfma_f32_16x16x32_bf16 v[220:223], v[24:27], v[56:59], v[220:223]
  v_mfma_f32_16x16x32_bf16 v[192:195], v[20:23], v[32:35], v[192:195]
  v_mfma_f32_16x16x32_bf16 v[196:199], v[28:31], v[32:35], v[196:199]
  v_mfma_f32_16x16x32_bf16 v[200:203], v[20:23], v[40:43], v[200:203]
  v_mfma_f32_16x16x32_bf16 v[204:207], v[28:31], v[40:43], v[204:207]
  v_mfma_f32_16x16x32_bf16 v[208:211], v[20:23], v[48:51], v[208:211]
  v_mfma_f32_16x16x32_bf16 v[212:215], v[28:31], v[48:51], v[212:215]
  v_mfma_f32_16x16x32_bf16 v[216:219], v[20:23], v[56:59], v[216:219]
  v_mfma_f32_16x16x32_bf16 v[220:223], v[28:31], v[56:59], v[220:223]
  v_mfma_f32_16x16x32_bf16 v[192:195], v[16:19], v[36:39], v[192:195]
  v_mfma_f32_16x16x32_bf16 v[196:199], v[24:27], v[36:39], v[196:199]
  v_mfma_f32_16x16x32_bf16 v[200:203], v[16:19], v[44:47], v[200:203]
  v_mfma_f32_16x16x32_bf16 v[204:207], v[24:27], v[44:47], v[204:207]
  v_mfma_f32_16x16x32_bf16 v[208:211], v[16:19], v[52:55], v[208:211]
  v_mfma_f32_16x16x32_bf16 v[212:215], v[24:27], v[52:55], v[212:215]
  v_mfma_f32_16x16x32_bf16 v[216:219], v[16:19], v[60:63], v[216:219]
  v_mfma_f32_16x16x32_bf16 v[220:223], v[24:27], v[60:63], v[220:223]
  v_and_b32 v1, 15, v0
  v_mul_u32_u24 v1, 144, v1
  v_lshrrev_b32 v4, 4, v0
  v_lshl_add_u32 v1, v4, 4, v1
  v_add_u32 v1, s78, v1
  s_lshl_b32 s73, s71, 6
  v_add_u32 v7, s73, v0
  v_sub_u32 v2, 2047, v7
  v_subrev_u32 v8, 0, v2
  v_cvt_f32_u32 v8, v8
  v_cvt_pk_bf16_f32 v8, v8, v8
  v_lshlrev_b32 v8, 16, v8
  v_cvt_u32_f32 v8, v8
  v_lshrrev_b32 v9, 5, v8
  v_and_b32 v10, 31, v8
  v_mul_u32_u24 v9, 144, v9
  v_lshl_add_u32 v64, v10, 2, v9
  v_subrev_u32 v8, 256, v2
  v_cvt_f32_u32 v8, v8
  v_cvt_pk_bf16_f32 v8, v8, v8
  v_lshlrev_b32 v8, 16, v8
  v_cvt_u32_f32 v8, v8
  v_lshrrev_b32 v9, 5, v8
  v_and_b32 v10, 31, v8
  v_mul_u32_u24 v9, 144, v9
  v_lshl_add_u32 v65, v10, 2, v9
  v_subrev_u32 v8, 512, v2
  v_cvt_f32_u32 v8, v8
  v_cvt_pk_bf16_f32 v8, v8, v8
  v_lshlrev_b32 v8, 16, v8
  v_cvt_u32_f32 v8, v8
  v_lshrrev_b32 v9, 5, v8
  v_and_b32 v10, 31, v8
  v_mul_u32_u24 v9, 144, v9
  v_lshl_add_u32 v66, v10, 2, v9
  v_subrev_u32 v8, 768, v2
  v_cvt_f32_u32 v8, v8
  v_cvt_pk_bf16_f32 v8, v8, v8
  v_lshlrev_b32 v8, 16, v8
  v_cvt_u32_f32 v8, v8
  v_lshrrev_b32 v9, 5, v8
  v_and_b32 v10, 31, v8
  v_mul_u32_u24 v9, 144, v9
  v_lshl_add_u32 v67, v10, 2, v9
  v_subrev_u32 v8, 1024, v2
  v_cvt_f32_u32 v8, v8
  v_cvt_pk_bf16_f32 v8, v8, v8
  v_lshlrev_b32 v8, 16, v8
  v_cvt_u32_f32 v8, v8
  v_lshrrev_b32 v9, 5, v8
  v_and_b32 v10, 31, v8
  v_mul_u32_u24 v9, 144, v9
  v_lshl_add_u32 v68, v10, 2, v9
  v_subrev_u32 v8, 1280, v2
  v_cvt_f32_u32 v8, v8
  v_cvt_pk_bf16_f32 v8, v8, v8
  v_lshlrev_b32 v8, 16, v8
  v_cvt_u32_f32 v8, v8
  v_lshrrev_b32 v9, 5, v8
  v_and_b32 v10, 31, v8
  v_mul_u32_u24 v9, 144, v9
  v_lshl_add_u32 v69, v10, 2, v9
  v_subrev_u32 v8, 1536, v2
  v_cvt_f32_u32 v8, v8
  v_cvt_pk_bf16_f32 v8, v8, v8
  v_lshlrev_b32 v8, 16, v8
  v_cvt_u32_f32 v8, v8
  v_lshrrev_b32 v9, 5, v8
  v_and_b32 v10, 31, v8
  v_mul_u32_u24 v9, 144, v9
  v_lshl_add_u32 v70, v10, 2, v9
  v_subrev_u32 v8, 1792, v2
  v_cvt_f32_u32 v8, v8
  v_cvt_pk_bf16_f32 v8, v8, v8
  v_lshlrev_b32 v8, 16, v8
  v_cvt_u32_f32 v8, v8
  v_lshrrev_b32 v9, 5, v8
  v_and_b32 v10, 31, v8
  v_mul_u32_u24 v9, 144, v9
  v_lshl_add_u32 v71, v10, 2, v9
  ds_write_b128 v1, v[192:195] offset:0
  ds_write_b128 v1, v[196:199] offset:64
  ds_write_b128 v1, v[200:203] offset:2304
  ds_write_b128 v1, v[204:207] offset:2368
  ds_write_b128 v1, v[208:211] offset:4608
  ds_write_b128 v1, v[212:215] offset:4672
  ds_write_b128 v1, v[216:219] offset:6912
  ds_write_b128 v1, v[220:223] offset:6976
  v_mov_b32 v72, 0
  s_waitcnt lgkmcnt(0)
  s_barrier
  ds_read_b32 v16, v64 offset:0
  ds_read_b32 v17, v64 offset:9360
  ds_read_b32 v18, v64 offset:18720
  ds_read_b32 v19, v64 offset:28080
  ds_read_b32 v20, v65 offset:0
  ds_read_b32 v21, v65 offset:9360
  ds_read_b32 v22, v65 offset:18720
  ds_read_b32 v23, v65 offset:28080
  ds_read_b32 v24, v66 offset:0
  ds_read_b32 v25, v66 offset:9360
  ds_read_b32 v26, v66 offset:18720
  ds_read_b32 v27, v66 offset:28080
  ds_read_b32 v28, v67 offset:0
  ds_read_b32 v29, v67 offset:9360
  ds_read_b32 v30, v67 offset:18720
  ds_read_b32 v31, v67 offset:28080
  ds_read_b32 v32, v68 offset:0
  ds_read_b32 v33, v68 offset:9360
  ds_read_b32 v34, v68 offset:18720
  ds_read_b32 v35, v68 offset:28080
  ds_read_b32 v36, v69 offset:0
  ds_read_b32 v37, v69 offset:9360
  ds_read_b32 v38, v69 offset:18720
  ds_read_b32 v39, v69 offset:28080
  ds_read_b32 v40, v70 offset:0
  ds_read_b32 v41, v70 offset:9360
  ds_read_b32 v42, v70 offset:18720
  ds_read_b32 v43, v70 offset:28080
  ds_read_b32 v44, v71 offset:0
  ds_read_b32 v45, v71 offset:9360
  ds_read_b32 v46, v71 offset:18720
  ds_read_b32 v47, v71 offset:28080
  ds_read_b32 v48, v72 offset:9220
  ds_read_b32 v49, v72 offset:18580
  ds_read_b32 v50, v72 offset:27940
  ds_read_b32 v51, v72 offset:37300
  v_lshlrev_b32 v3, 1, v7
  v_add_u32 v3, 52864, v3
  v_mov_b32 v56, 0
  v_mov_b32 v57, 0
  v_mov_b32 v58, 0
  v_mov_b32 v59, 0
  v_mov_b32 v4, 52864
  ds_write_b128 v4, v[56:59] offset:4096
  ds_write_b128 v4, v[56:59] offset:4112
  ds_write_b128 v4, v[56:59] offset:4128
  ds_write_b128 v4, v[56:59] offset:4144
  s_waitcnt lgkmcnt(4)
  v_add_f32 v48, v48, v49
  v_add_f32 v50, v50, v51
  v_add_f32 v48, v48, v50
  v_frexp_exp_i32_f32 v49, v48
  v_sub_u32 v50, 14, v49
  v_subrev_u32 v51, 14, v49
  v_ldexp_f32 v50, 1.0, v50
  v_ldexp_f32 v241, 1.0, v51
  v_add_f32 v16, v16, v17
  v_add_f32 v18, v18, v19
  v_add_f32 v16, v16, v18
  v_mul_f32 v16, v50, v16
  v_cvt_f16_f32 v16, v16
  ds_write_b16 v3, v16 offset:0
  v_add_f32 v20, v20, v21
  v_add_f32 v22, v22, v23
  v_add_f32 v20, v20, v22
  v_mul_f32 v20, v50, v20
  v_cvt_f16_f32 v20, v20
  ds_write_b16 v3, v20 offset:512
  v_add_f32 v24, v24, v25
  v_add_f32 v26, v26, v27
  v_add_f32 v24, v24, v26
  v_mul_f32 v24, v50, v24
  v_cvt_f16_f32 v24, v24
  ds_write_b16 v3, v24 offset:1024
  v_add_f32 v28, v28, v29
  v_add_f32 v30, v30, v31
  v_add_f32 v28, v28, v30
  v_mul_f32 v28, v50, v28
  v_cvt_f16_f32 v28, v28
  ds_write_b16 v3, v28 offset:1536
  v_add_f32 v32, v32, v33
  v_add_f32 v34, v34, v35
  v_add_f32 v32, v32, v34
  v_mul_f32 v32, v50, v32
  v_cvt_f16_f32 v32, v32
  ds_write_b16 v3, v32 offset:2048
  v_add_f32 v36, v36, v37
  v_add_f32 v38, v38, v39
  v_add_f32 v36, v36, v38
  v_mul_f32 v36, v50, v36
  v_cvt_f16_f32 v36, v36
  ds_write_b16 v3, v36 offset:2560
  v_add_f32 v40, v40, v41
  v_add_f32 v42, v42, v43
  v_add_f32 v40, v40, v42
  v_mul_f32 v40, v50, v40
  v_cvt_f16_f32 v40, v40
  ds_write_b16 v3, v40 offset:3072
  v_add_f32 v44, v44, v45
  v_add_f32 v46, v46, v47
  v_add_f32 v44, v44, v46
  v_mul_f32 v44, v50, v44
  v_cvt_f16_f32 v44, v44
  ds_write_b16 v3, v44 offset:3584
  s_cmp_lg_u32 s50, 0
  s_cbranch_scc1 Lng_20
  v_mov_b32 v244, 0
  s_mov_b32 s6, 0
Lngp_21:
  global_load_dwordx2 v[246:247], v244, s[44:45] sc1
  s_waitcnt vmcnt(0)
  v_cmp_eq_u32 vcc, 0, v246
  s_add_u32 s6, s6, 1
  s_cmp_gt_u32 s6, 200000
  s_cbranch_scc1 Lngd_22
  s_cbranch_vccz Lngd_22
  s_sleep 2
  s_branch Lngp_21
Lngd_22:
  v_readfirstlane_b32 s8, v246
  v_readfirstlane_b32 s9, v247
Lng_20:
  s_waitcnt lgkmcnt(0)
  s_cmp_lg_u32 s50, 0
  s_cbranch_scc1 Lpl_23
  v_lshlrev_b32 v244, 3, v0
  v_add_u32 v244, 12582912, v244
  s_mov_b32 s6, 0
Lplp_24:
  global_load_dwordx2 v[246:247], v244, s[46:47] offset:0 sc1
  global_load_dwordx2 v[248:249], v244, s[46:47] offset:512 sc1
  global_load_dwordx2 v[250:251], v244, s[46:47] offset:1024 sc1
  global_load_dwordx2 v[252:253], v244, s[46:47] offset:1536 sc1
  s_waitcnt vmcnt(0)
  v_xor_b32 v246, s8, v246
  v_xor_b32 v247, s9, v247
  v_xor_b32 v248, s8, v248
  v_xor_b32 v249, s9, v249
  v_xor_b32 v250, s8, v250
  v_xor_b32 v251, s9, v251
  v_xor_b32 v252, s8, v252
  v_xor_b32 v253, s9, v253
  v_or_b32 v246, v246, v247
  v_or_b32 v246, v246, v248
  v_or_b32 v246, v246, v249
  v_or_b32 v246, v246, v250
  v_or_b32 v246, v246, v251
  v_or_b32 v246, v246, v252
  v_or_b32 v246, v246, v253
  v_cmp_ne_u32 vcc, 0, v246
  s_add_u32 s6, s6, 1
  s_cmp_gt_u32 s6, 200000
  s_cbranch_scc1 Lpld_25
  s_cbranch_vccz Lpld_25
  s_sleep 4
  s_branch Lplp_24
Lpld_25:
Lpl_23:
  s_barrier
  s_lshl_b32 s73, s50, 6
  v_add_u32 v1, s73, v0
  s_lshr_b32 s75, s72, 3
  s_lshl_b32 s75, s75, 11
  s_and_b32 s74, s72, 7
  s_lshl_b32 s74, s74, 1
  s_add_u32 s75, s75, s74
  s_add_u32 s74, s46, s75
  s_addc_u32 s75, s47, 0
  v_lshrrev_b32 v2, 7, v1
  v_lshlrev_b32 v2, 17, v2
  v_and_b32 v3, 127, v1
  v_lshl_add_u32 v2, v3, 4, v2
  global_load_dword v8, v2, s[74:75] sc1
  v_add_u32 v2, 0x40000, v2
  global_load_dword v9, v2, s[74:75] sc1
  v_add_u32 v2, 0x40000, v2
  global_load_dword v10, v2, s[74:75] sc1
  v_add_u32 v2, 0x40000, v2
  global_load_dword v11, v2, s[74:75] sc1
  v_add_u32 v2, 0x40000, v2
  global_load_dword v12, v2, s[74:75] sc1
  v_add_u32 v2, 0x40000, v2
  global_load_dword v13, v2, s[74:75] sc1
  v_add_u32 v2, 0x40000, v2
  global_load_dword v14, v2, s[74:75] sc1
  v_add_u32 v2, 0x40000, v2
  global_load_dword v15, v2, s[74:75] sc1
  v_mov_b32 v56, 0
  v_mov_b32 v57, 0
  v_mov_b32 v58, 0
  v_mov_b32 v59, 0
  v_cmp_gt_u32 vcc, 160, v1
  v_lshlrev_b32 v3, 4, v1
  v_add_u32 v3, 33280, v3
  s_and_saveexec_b64 s[76:77], vcc
  ds_write_b128 v3, v[56:59]
  ds_write_b128 v3, v[56:59] offset:7680
  s_mov_b64 exec, s[76:77]
  v_lshrrev_b32 v3, 5, v1
  v_mul_u32_u24 v3, 80, v3
  v_and_b32 v4, 31, v1
  v_lshl_add_u32 v3, v4, 1, v3
  v_add_u32 v3, 35840, v3
  s_lshl_b32 s74, s71, 6
  v_add_u32 v1, s74, v0
  v_lshlrev_b32 v5, 4, v1
  v_add_u32 v4, 0, v5
  v_add_u32 v5, 48640, v5
  ds_read_b128 v[64:67], v5
  ds_read_b128 v[68:71], v5 offset:16
  s_waitcnt lgkmcnt(0)
  v_alignbit_b32 v72, v68, v67, 16
  v_alignbit_b32 v73, v69, v68, 16
  v_alignbit_b32 v74, v70, v69, 16
  v_alignbit_b32 v75, v71, v70, 16
  ds_write_b128 v4, v[72:75] offset:0
  v_mov_b32 v76, v67
  v_mov_b32 v77, v68
  v_mov_b32 v78, v69
  v_mov_b32 v79, v70
  ds_write_b128 v4, v[76:79] offset:4160
  v_alignbit_b32 v80, v67, v66, 16
  v_alignbit_b32 v81, v68, v67, 16
  v_alignbit_b32 v82, v69, v68, 16
  v_alignbit_b32 v83, v70, v69, 16
  ds_write_b128 v4, v[80:83] offset:8320
  v_mov_b32 v84, v66
  v_mov_b32 v85, v67
  v_mov_b32 v86, v68
  v_mov_b32 v87, v69
  ds_write_b128 v4, v[84:87] offset:12480
  v_alignbit_b32 v88, v66, v65, 16
  v_alignbit_b32 v89, v67, v66, 16
  v_alignbit_b32 v90, v68, v67, 16
  v_alignbit_b32 v91, v69, v68, 16
  ds_write_b128 v4, v[88:91] offset:16640
  v_mov_b32 v92, v65
  v_mov_b32 v93, v66
  v_mov_b32 v94, v67
  v_mov_b32 v95, v68
  ds_write_b128 v4, v[92:95] offset:20800
  v_alignbit_b32 v96, v65, v64, 16
  v_alignbit_b32 v97, v66, v65, 16
  v_alignbit_b32 v98, v67, v66, 16
  v_alignbit_b32 v99, v68, v67, 16
  ds_write_b128 v4, v[96:99] offset:24960
  v_mov_b32 v100, v64
  v_mov_b32 v101, v65
  v_mov_b32 v102, v66
  v_mov_b32 v103, v67
  ds_write_b128 v4, v[100:103] offset:29120
  s_cmp_lg_u32 s71, 0
  s_cbranch_scc1 Lkcskip_26
  v_cmp_gt_u32 vcc, 3, v0
  s_and_saveexec_b64 s[76:77], vcc
  v_add_u32 v2, 256, v0
  v_lshlrev_b32 v5, 4, v2
  v_add_u32 v4, 0, v5
  v_add_u32 v5, 48640, v5
  ds_read_b128 v[64:67], v5
  ds_read_b128 v[68:71], v5 offset:16
  s_waitcnt lgkmcnt(0)
  v_alignbit_b32 v72, v68, v67, 16
  v_alignbit_b32 v73, v69, v68, 16
  v_alignbit_b32 v74, v70, v69, 16
  v_alignbit_b32 v75, v71, v70, 16
  ds_write_b128 v4, v[72:75] offset:0
  v_mov_b32 v76, v67
  v_mov_b32 v77, v68
  v_mov_b32 v78, v69
  v_mov_b32 v79, v70
  ds_write_b128 v4, v[76:79] offset:4160
  v_alignbit_b32 v80, v67, v66, 16
  v_alignbit_b32 v81, v68, v67, 16
  v_alignbit_b32 v82, v69, v68, 16
  v_alignbit_b32 v83, v70, v69, 16
  ds_write_b128 v4, v[80:83] offset:8320
  v_mov_b32 v84, v66
  v_mov_b32 v85, v67
  v_mov_b32 v86, v68
  v_mov_b32 v87, v69
  ds_write_b128 v4, v[84:87] offset:12480
  v_alignbit_b32 v88, v66, v65, 16
  v_alignbit_b32 v89, v67, v66, 16
  v_alignbit_b32 v90, v68, v67, 16
  v_alignbit_b32 v91, v69, v68, 16
  ds_write_b128 v4, v[88:91] offset:16640
  v_mov_b32 v92, v65
  v_mov_b32 v93, v66
  v_mov_b32 v94, v67
  v_mov_b32 v95, v68
  ds_write_b128 v4, v[92:95] offset:20800
  v_alignbit_b32 v96, v65, v64, 16
  v_alignbit_b32 v97, v66, v65, 16
  v_alignbit_b32 v98, v67, v66, 16
  v_alignbit_b32 v99, v68, v67, 16
  ds_write_b128 v4, v[96:99] offset:24960
  v_mov_b32 v100, v64
  v_mov_b32 v101, v65
  v_mov_b32 v102, v66
  v_mov_b32 v103, v67
  ds_write_b128 v4, v[100:103] offset:29120
  s_mov_b64 exec, s[76:77]
Lkcskip_26:
  s_waitcnt vmcnt(0)
  v_lshlrev_b32 v16, 16, v8
  v_and_b32 v17, 0xffff0000, v8
  v_cvt_f16_f32 v16, v16
  v_cvt_f16_f32 v17, v17
  ds_write_b16 v3, v16 offset:0
  ds_write_b16 v3, v17 offset:7680
  v_lshlrev_b32 v16, 16, v9
  v_and_b32 v17, 0xffff0000, v9
  v_cvt_f16_f32 v16, v16
  v_cvt_f16_f32 v17, v17
  ds_write_b16 v3, v16 offset:640
  ds_write_b16 v3, v17 offset:8320
  v_lshlrev_b32 v16, 16, v10
  v_and_b32 v17, 0xffff0000, v10
  v_cvt_f16_f32 v16, v16
  v_cvt_f16_f32 v17, v17
  ds_write_b16 v3, v16 offset:1280
  ds_write_b16 v3, v17 offset:8960
  v_lshlrev_b32 v16, 16, v11
  v_and_b32 v17, 0xffff0000, v11
  v_cvt_f16_f32 v16, v16
  v_cvt_f16_f32 v17, v17
  ds_write_b16 v3, v16 offset:1920
  ds_write_b16 v3, v17 offset:9600
  v_lshlrev_b32 v16, 16, v12
  v_and_b32 v17, 0xffff0000, v12
  v_cvt_f16_f32 v16, v16
  v_cvt_f16_f32 v17, v17
  ds_write_b16 v3, v16 offset:2560
  ds_write_b16 v3, v17 offset:10240
  v_lshlrev_b32 v16, 16, v13
  v_and_b32 v17, 0xffff0000, v13
  v_cvt_f16_f32 v16, v16
  v_cvt_f16_f32 v17, v17
  ds_write_b16 v3, v16 offset:3200
  ds_write_b16 v3, v17 offset:10880
  v_lshlrev_b32 v16, 16, v14
  v_and_b32 v17, 0xffff0000, v14
  v_cvt_f16_f32 v16, v16
  v_cvt_f16_f32 v17, v17
  ds_write_b16 v3, v16 offset:3840
  ds_write_b16 v3, v17 offset:11520
  v_lshlrev_b32 v16, 16, v15
  v_and_b32 v17, 0xffff0000, v15
  v_cvt_f16_f32 v16, v16
  v_cvt_f16_f32 v17, v17
  ds_write_b16 v3, v16 offset:4480
  ds_write_b16 v3, v17 offset:12160
  s_waitcnt lgkmcnt(0)
  s_barrier
  v_and_b32 v1, 31, v0
  v_lshrrev_b32 v2, 5, v0
  v_and_b32 v3, 7, v1
  v_lshrrev_b32 v4, 3, v1
  v_mul_u32_u24 v3, 4160, v3
  v_sub_u32 v4, v2, v4
  v_add_u32 v4, 255, v4
  v_lshl_add_u32 v3, v4, 4, v3
  s_lshl_b32 s73, s71, 9
  s_add_u32 s73, s73, 2496
  s_sub_u32 s74, 0, s73
  v_add_u32 v5, s74, v3
  v_mul_u32_u24 v6, 80, v1
  v_lshl_add_u32 v6, v2, 4, v6
  s_lshl_b32 s73, s71, 3
  s_sub_u32 s73, 25, s73
  s_mul_i32 s73, s73, 80
  s_add_u32 s73, s73, 33280
  v_add_u32 v6, s73, v6
  v_mov_b32 v192, 0
  v_mov_b32 v193, 0
  v_mov_b32 v194, 0
  v_mov_b32 v195, 0
  v_mov_b32 v196, 0
  v_mov_b32 v197, 0
  v_mov_b32 v198, 0
  v_mov_b32 v199, 0
  v_mov_b32 v200, 0
  v_mov_b32 v201, 0
  v_mov_b32 v202, 0
  v_mov_b32 v203, 0
  v_mov_b32 v204, 0
  v_mov_b32 v205, 0
  v_mov_b32 v206, 0
  v_mov_b32 v207, 0
  v_mov_b32 v208, 0
  v_mov_b32 v209, 0
  v_mov_b32 v210, 0
  v_mov_b32 v211, 0
  v_mov_b32 v212, 0
  v_mov_b32 v213, 0
  v_mov_b32 v214, 0
  v_mov_b32 v215, 0
  v_mov_b32 v216, 0
  v_mov_b32 v217, 0
  v_mov_b32 v218, 0
  v_mov_b32 v219, 0
  v_mov_b32 v220, 0
  v_mov_b32 v221, 0
  v_mov_b32 v222, 0
  v_mov_b32 v223, 0
  ds_read_b128 v[8:11], v5 offset:2496
  ds_read_b128 v[12:15], v5 offset:448
  ds_read_b128 v[16:19], v6 offset:560
  ds_read_b128 v[20:23], v6 offset:3120
  ds_read_b128 v[24:27], v5 offset:2528
  ds_read_b128 v[28:31], v5 offset:480
  ds_read_b128 v[32:35], v6 offset:592
  ds_read_b128 v[36:39], v6 offset:3152
  ds_read_b128 v[40:43], v5 offset:2432
  ds_read_b128 v[44:47], v5 offset:384
  ds_read_b128 v[48:51], v6 offset:480
  ds_read_b128 v[52:55], v6 offset:3040
  ds_read_b128 v[56:59], v5 offset:2464
  ds_read_b128 v[60:63], v5 offset:416
  ds_read_b128 v[64:67], v6 offset:512
  ds_read_b128 v[68:71], v6 offset:3072
  s_waitcnt lgkmcnt(8)
  v_mfma_f32_32x32x16_f16 v[192:207], v[8:11], v[16:19], v[192:207]
  v_mfma_f32_32x32x16_f16 v[208:223], v[8:11], v[20:23], v[208:223]
  v_mfma_f32_32x32x16_f16 v[208:223], v[12:15], v[16:19], v[208:223]
  v_mfma_f32_32x32x16_f16 v[192:207], v[24:27], v[32:35], v[192:207]
  v_mfma_f32_32x32x16_f16 v[208:223], v[24:27], v[36:39], v[208:223]
  v_mfma_f32_32x32x16_f16 v[208:223], v[28:31], v[32:35], v[208:223]
  ds_read_b128 v[8:11], v5 offset:2368
  ds_read_b128 v[12:15], v5 offset:320
  ds_read_b128 v[16:19], v6 offset:400
  ds_read_b128 v[20:23], v6 offset:2960
  ds_read_b128 v[24:27], v5 offset:2400
  ds_read_b128 v[28:31], v5 offset:352
  ds_read_b128 v[32:35], v6 offset:432
  ds_read_b128 v[36:39], v6 offset:2992
  s_waitcnt lgkmcnt(8)
  v_mfma_f32_32x32x16_f16 v[192:207], v[40:43], v[48:51], v[192:207]
  v_mfma_f32_32x32x16_f16 v[208:223], v[40:43], v[52:55], v[208:223]
  v_mfma_f32_32x32x16_f16 v[208:223], v[44:47], v[48:51], v[208:223]
  v_mfma_f32_32x32x16_f16 v[192:207], v[56:59], v[64:67], v[192:207]
  v_mfma_f32_32x32x16_f16 v[208:223], v[56:59], v[68:71], v[208:223]
  v_mfma_f32_32x32x16_f16 v[208:223], v[60:63], v[64:67], v[208:223]
  ds_read_b128 v[40:43], v5 offset:2304
  ds_read_b128 v[44:47], v5 offset:256
  ds_read_b128 v[48:51], v6 offset:320
  ds_read_b128 v[52:55], v6 offset:2880
  ds_read_b128 v[56:59], v5 offset:2336
  ds_read_b128 v[60:63], v5 offset:288
  ds_read_b128 v[64:67], v6 offset:352
  ds_read_b128 v[68:71], v6 offset:2912
  s_waitcnt lgkmcnt(8)
  v_mfma_f32_32x32x16_f16 v[192:207], v[8:11], v[16:19], v[192:207]
  v_mfma_f32_32x32x16_f16 v[208:223], v[8:11], v[20:23], v[208:223]
  v_mfma_f32_32x32x16_f16 v[208:223], v[12:15], v[16:19], v[208:223]
  v_mfma_f32_32x32x16_f16 v[192:207], v[24:27], v[32:35], v[192:207]
  v_mfma_f32_32x32x16_f16 v[208:223], v[24:27], v[36:39], v[208:223]
  v_mfma_f32_32x32x16_f16 v[208:223], v[28:31], v[32:35], v[208:223]
  ds_read_b128 v[8:11], v5 offset:2240
  ds_read_b128 v[12:15], v5 offset:192
  ds_read_b128 v[16:19], v6 offset:240
  ds_read_b128 v[20:23], v6 offset:2800
  ds_read_b128 v[24:27], v5 offset:2272
  ds_read_b128 v[28:31], v5 offset:224
  ds_read_b128 v[32:35], v6 offset:272
  ds_read_b128 v[36:39], v6 offset:2832
  s_waitcnt lgkmcnt(8)
  v_mfma_f32_32x32x16_f16 v[192:207], v[40:43], v[48:51], v[192:207]
  v_mfma_f32_32x32x16_f16 v[208:223], v[40:43], v[52:55], v[208:223]
  v_mfma_f32_32x32x16_f16 v[208:223], v[44:47], v[48:51], v[208:223]
  v_mfma_f32_32x32x16_f16 v[192:207], v[56:59], v[64:67], v[192:207]
  v_mfma_f32_32x32x16_f16 v[208:223], v[56:59], v[68:71], v[208:223]
  v_mfma_f32_32x32x16_f16 v[208:223], v[60:63], v[64:67], v[208:223]
  ds_read_b128 v[40:43], v5 offset:2176
  ds_read_b128 v[44:47], v5 offset:128
  ds_read_b128 v[48:51], v6 offset:160
  ds_read_b128 v[52:55], v6 offset:2720
  ds_read_b128 v[56:59], v5 offset:2208
  ds_read_b128 v[60:63], v5 offset:160
  ds_read_b128 v[64:67], v6 offset:192
  ds_read_b128 v[68:71], v6 offset:2752
  s_waitcnt lgkmcnt(8)
  v_mfma_f32_32x32x16_f16 v[192:207], v[8:11], v[16:19], v[192:207]
  v_mfma_f32_32x32x16_f16 v[208:223], v[8:11], v[20:23], v[208:223]
  v_mfma_f32_32x32x16_f16 v[208:223], v[12:15], v[16:19], v[208:223]
  v_mfma_f32_32x32x16_f16 v[192:207], v[24:27], v[32:35], v[192:207]
  v_mfma_f32_32x32x16_f16 v[208:223], v[24:27], v[36:39], v[208:223]
  v_mfma_f32_32x32x16_f16 v[208:223], v[28:31], v[32:35], v[208:223]
  ds_read_b128 v[8:11], v5 offset:2112
  ds_read_b128 v[12:15], v5 offset:64
  ds_read_b128 v[16:19], v6 offset:80
  ds_read_b128 v[20:23], v6 offset:2640
  ds_read_b128 v[24:27], v5 offset:2144
  ds_read_b128 v[28:31], v5 offset:96
  ds_read_b128 v[32:35], v6 offset:112
  ds_read_b128 v[36:39], v6 offset:2672
  s_waitcnt lgkmcnt(8)
  v_mfma_f32_32x32x16_f16 v[192:207], v[40:43], v[48:51], v[192:207]
  v_mfma_f32_32x32x16_f16 v[208:223], v[40:43], v[52:55], v[208:223]
  v_mfma_f32_32x32x16_f16 v[208:223], v[44:47], v[48:51], v[208:223]
  v_mfma_f32_32x32x16_f16 v[192:207], v[56:59], v[64:67], v[192:207]
  v_mfma_f32_32x32x16_f16 v[208:223], v[56:59], v[68:71], v[208:223]
  v_mfma_f32_32x32x16_f16 v[208:223], v[60:63], v[64:67], v[208:223]
  ds_read_b128 v[40:43], v5 offset:2048
  ds_read_b128 v[44:47], v5 offset:0
  ds_read_b128 v[48:51], v6 offset:0
  ds_read_b128 v[52:55], v6 offset:2560
  ds_read_b128 v[56:59], v5 offset:2080
  ds_read_b128 v[60:63], v5 offset:32
  ds_read_b128 v[64:67], v6 offset:32
  ds_read_b128 v[68:71], v6 offset:2592
  s_waitcnt lgkmcnt(8)
  v_mfma_f32_32x32x16_f16 v[192:207], v[8:11], v[16:19], v[192:207]
  v_mfma_f32_32x32x16_f16 v[208:223], v[8:11], v[20:23], v[208:223]
  v_mfma_f32_32x32x16_f16 v[208:223], v[12:15], v[16:19], v[208:223]
  v_mfma_f32_32x32x16_f16 v[192:207], v[24:27], v[32:35], v[192:207]
  v_mfma_f32_32x32x16_f16 v[208:223], v[24:27], v[36:39], v[208:223]
  v_mfma_f32_32x32x16_f16 v[208:223], v[28:31], v[32:35], v[208:223]
  s_waitcnt lgkmcnt(0)
  v_mfma_f32_32x32x16_f16 v[192:207], v[40:43], v[48:51], v[192:207]
  v_mfma_f32_32x32x16_f16 v[208:223], v[40:43], v[52:55], v[208:223]
  v_mfma_f32_32x32x16_f16 v[208:223], v[44:47], v[48:51], v[208:223]
  v_mfma_f32_32x32x16_f16 v[192:207], v[56:59], v[64:67], v[192:207]
  v_mfma_f32_32x32x16_f16 v[208:223], v[56:59], v[68:71], v[208:223]
  v_mfma_f32_32x32x16_f16 v[208:223], v[60:63], v[64:67], v[208:223]
  v_lshlrev_b32 v1, 4, v0
  s_nop 7
  s_cmp_eq_u32 s71, 0
  s_cbranch_scc1 Lrs_27
  s_sub_u32 s73, s71, 1
  s_and_b32 s73, s73, 3
  s_lshl_b32 s73, s73, 11
  s_add_u32 s73, s73, 57088
  v_add_u32 v2, s73, v1
  ds_write_b128 v2, v[192:195]
  ds_write_b128 v2, v[196:199] offset:1024
Lrs_27:
  s_cmp_eq_u32 s71, 1
  s_cbranch_scc1 Lrs_28
  s_sub_u32 s73, s71, 2
  s_and_b32 s73, s73, 3
  s_lshl_b32 s73, s73, 11
  s_add_u32 s73, s73, 63232
  v_add_u32 v2, s73, v1
  ds_write_b128 v2, v[200:203]
  ds_write_b128 v2, v[204:207] offset:1024
Lrs_28:
  s_cmp_eq_u32 s71, 2
  s_cbranch_scc1 Lrs_29
  s_sub_u32 s73, s71, 3
  s_and_b32 s73, s73, 3
  s_lshl_b32 s73, s73, 11
  s_add_u32 s73, s73, 69376
  v_add_u32 v2, s73, v1
  ds_write_b128 v2, v[208:211]
  ds_write_b128 v2, v[212:215] offset:1024
Lrs_29:
  s_cmp_eq_u32 s71, 3
  s_cbranch_scc1 Lrs_30
  s_sub_u32 s73, s71, 4
  s_and_b32 s73, s73, 3
  s_lshl_b32 s73, s73, 11
  s_add_u32 s73, s73, 75520
  v_add_u32 v2, s73, v1
  ds_write_b128 v2, v[216:219]
  ds_write_b128 v2, v[220:223] offset:1024
Lrs_30:
  s_cmp_lg_u32 s71, 0
  s_cbranch_scc1 Lmv_32
  v_mov_b32 v8, v192
  v_mov_b32 v9, v193
  v_mov_b32 v10, v194
  v_mov_b32 v11, v195
  v_mov_b32 v12, v196
  v_mov_b32 v13, v197
  v_mov_b32 v14, v198
  v_mov_b32 v15, v199
  s_branch Lmvd_31
Lmv_32:
  s_cmp_lg_u32 s71, 1
  s_cbranch_scc1 Lmv_33
  v_mov_b32 v8, v200
  v_mov_b32 v9, v201
  v_mov_b32 v10, v202
  v_mov_b32 v11, v203
  v_mov_b32 v12, v204
  v_mov_b32 v13, v205
  v_mov_b32 v14, v206
  v_mov_b32 v15, v207
  s_branch Lmvd_31
Lmv_33:
  s_cmp_lg_u32 s71, 2
  s_cbranch_scc1 Lmv_34
  v_mov_b32 v8, v208
  v_mov_b32 v9, v209
  v_mov_b32 v10, v210
  v_mov_b32 v11, v211
  v_mov_b32 v12, v212
  v_mov_b32 v13, v213
  v_mov_b32 v14, v214
  v_mov_b32 v15, v215
  s_branch Lmvd_31
Lmv_34:
  s_cmp_lg_u32 s71, 3
  s_cbranch_scc1 Lmv_35
  v_mov_b32 v8, v216
  v_mov_b32 v9, v217
  v_mov_b32 v10, v218
  v_mov_b32 v11, v219
  v_mov_b32 v12, v220
  v_mov_b32 v13, v221
  v_mov_b32 v14, v222
  v_mov_b32 v15, v223
  s_branch Lmvd_31
Lmv_35:
Lmvd_31:
  s_waitcnt lgkmcnt(0)
  s_barrier
  s_mul_i32 s73, s71, 6144
  s_add_u32 s73, s73, 57088
  v_add_u32 v2, s73, v1
  ds_read_b128 v[16:19], v2 offset:0
  ds_read_b128 v[20:23], v2 offset:1024
  ds_read_b128 v[24:27], v2 offset:2048
  ds_read_b128 v[28:31], v2 offset:3072
  ds_read_b128 v[32:35], v2 offset:4096
  ds_read_b128 v[36:39], v2 offset:5120
  v_and_b32 v3, 31, v0
  v_lshrrev_b32 v4, 5, v0
  s_lshr_b32 s73, s71, 1
  s_lshl_b32 s73, s73, 5
  s_and_b32 s74, s71, 1
  s_lshl_b32 s74, s74, 4
  v_add_u32 v5, s73, v3
  v_mul_u32_u24 v6, 80, v5
  v_lshl_add_u32 v6, v4, 3, v6
  s_lshl_b32 s76, s74, 1
  s_add_u32 s75, s76, 35840
  v_add_u32 v6, s75, v6
  ds_read_b64 v[40:41], v6
  ds_read_b64 v[42:43], v6 offset:16
  v_lshlrev_b32 v5, 5, v5
  v_lshl_add_u32 v5, v4, 2, v5
  v_add_u32 v5, s74, v5
  v_lshlrev_b32 v5, 1, v5
  s_add_u32 s75, s72, 0
  s_lshl_b32 s75, s75, 12
  s_add_u32 s74, s46, s75
  s_addc_u32 s75, s47, 0
  s_add_u32 s74, s74, 9437184
  s_addc_u32 s75, s75, 0
  s_waitcnt lgkmcnt(0)
  v_add_f32 v8, v8, v16
  v_add_f32 v24, v24, v32
  v_add_f32 v8, v8, v24
  v_mul_f32 v8, v240, v8
  v_add_f32 v9, v9, v17
  v_add_f32 v25, v25, v33
  v_add_f32 v9, v9, v25
  v_mul_f32 v9, v240, v9
  v_add_f32 v10, v10, v18
  v_add_f32 v26, v26, v34
  v_add_f32 v10, v10, v26
  v_mul_f32 v10, v240, v10
  v_add_f32 v11, v11, v19
  v_add_f32 v27, v27, v35
  v_add_f32 v11, v11, v27
  v_mul_f32 v11, v240, v11
  v_add_f32 v12, v12, v20
  v_add_f32 v28, v28, v36
  v_add_f32 v12, v12, v28
  v_mul_f32 v12, v240, v12
  v_add_f32 v13, v13, v21
  v_add_f32 v29, v29, v37
  v_add_f32 v13, v13, v29
  v_mul_f32 v13, v240, v13
  v_add_f32 v14, v14, v22
  v_add_f32 v30, v30, v38
  v_add_f32 v14, v14, v30
  v_mul_f32 v14, v240, v14
  v_add_f32 v15, v15, v23
  v_add_f32 v31, v31, v39
  v_add_f32 v15, v15, v31
  v_mul_f32 v15, v240, v15
  v_cvt_f32_f16 v44, v40
  v_cvt_f32_f16 v46, v41
  v_cvt_f32_f16 v48, v42
  v_cvt_f32_f16 v50, v43
  v_cvt_f32_f16_sdwa v45, v40 dst_sel:DWORD dst_unused:UNUSED_PAD src0_sel:WORD_1
  v_cvt_f32_f16_sdwa v47, v41 dst_sel:DWORD dst_unused:UNUSED_PAD src0_sel:WORD_1
  v_cvt_f32_f16_sdwa v49, v42 dst_sel:DWORD dst_unused:UNUSED_PAD src0_sel:WORD_1
  v_cvt_f32_f16_sdwa v51, v43 dst_sel:DWORD dst_unused:UNUSED_PAD src0_sel:WORD_1
  v_mul_f32 v44, v231, v44
  v_mul_f32 v46, v231, v46
  v_mul_f32 v48, v231, v48
  v_mul_f32 v50, v231, v50
  v_mul_f32 v45, v231, v45
  v_mul_f32 v47, v231, v47
  v_mul_f32 v49, v231, v49
  v_mul_f32 v51, v231, v51
  v_cvt_pk_bf16_f32 v52, v44, v45
  v_cvt_pk_bf16_f32 v53, v46, v47
  v_cvt_pk_bf16_f32 v54, v48, v49
  v_cvt_pk_bf16_f32 v55, v50, v51
  v_cvt_pk_bf16_f32 v56, v8, v9
  v_cvt_pk_bf16_f32 v57, v10, v11
  v_cvt_pk_bf16_f32 v58, v12, v13
  v_cvt_pk_bf16_f32 v59, v14, v15
  v_lshlrev_b32 v44, 16, v52
  v_lshlrev_b32 v46, 16, v53
  v_lshlrev_b32 v48, 16, v54
  v_lshlrev_b32 v50, 16, v55
  v_and_b32 v45, 0xffff0000, v52
  v_and_b32 v47, 0xffff0000, v53
  v_and_b32 v49, 0xffff0000, v54
  v_and_b32 v51, 0xffff0000, v55
  v_lshlrev_b32 v8, 16, v56
  v_lshlrev_b32 v10, 16, v57
  v_lshlrev_b32 v12, 16, v58
  v_lshlrev_b32 v14, 16, v59
  v_and_b32 v9, 0xffff0000, v56
  v_and_b32 v11, 0xffff0000, v57
  v_and_b32 v13, 0xffff0000, v58
  v_and_b32 v15, 0xffff0000, v59
  v_add_f32 v8, v8, v44
  v_add_f32 v10, v10, v46
  v_add_f32 v12, v12, v48
  v_add_f32 v14, v14, v50
  v_add_f32 v9, v9, v45
  v_add_f32 v11, v11, v47
  v_add_f32 v13, v13, v49
  v_add_f32 v15, v15, v51
  v_cvt_pk_bf16_f32 v60, v8, v9
  v_cvt_pk_bf16_f32 v61, v10, v11
  v_cvt_pk_bf16_f32 v62, v12, v13
  v_cvt_pk_bf16_f32 v63, v14, v15
  global_store_dwordx2 v5, v[60:61], s[74:75] sc1
  global_store_dwordx2 v5, v[62:63], s[74:75] offset:16 sc1
  s_barrier
  s_lshl_b32 s74, s71, 6
  v_add_u32 v1, s74, v0
  v_lshlrev_b32 v5, 4, v1
  v_add_u32 v4, 0, v5
  v_add_u32 v5, 52864, v5
  ds_read_b128 v[64:67], v5
  ds_read_b128 v[68:71], v5 offset:16
  s_waitcnt lgkmcnt(0)
  v_alignbit_b32 v72, v68, v67, 16
  v_alignbit_b32 v73, v69, v68, 16
  v_alignbit_b32 v74, v70, v69, 16
  v_alignbit_b32 v75, v71, v70, 16
  ds_write_b128 v4, v[72:75] offset:0
  v_mov_b32 v76, v67
  v_mov_b32 v77, v68
  v_mov_b32 v78, v69
  v_mov_b32 v79, v70
  ds_write_b128 v4, v[76:79] offset:4160
  v_alignbit_b32 v80, v67, v66, 16
  v_alignbit_b32 v81, v68, v67, 16
  v_alignbit_b32 v82, v69, v68, 16
  v_alignbit_b32 v83, v70, v69, 16
  ds_write_b128 v4, v[80:83] offset:8320
  v_mov_b32 v84, v66
  v_mov_b32 v85, v67
  v_mov_b32 v86, v68
  v_mov_b32 v87, v69
  ds_write_b128 v4, v[84:87] offset:12480
  v_alignbit_b32 v88, v66, v65, 16
  v_alignbit_b32 v89, v67, v66, 16
  v_alignbit_b32 v90, v68, v67, 16
  v_alignbit_b32 v91, v69, v68, 16
  ds_write_b128 v4, v[88:91] offset:16640
  v_mov_b32 v92, v65
  v_mov_b32 v93, v66
  v_mov_b32 v94, v67
  v_mov_b32 v95, v68
  ds_write_b128 v4, v[92:95] offset:20800
  v_alignbit_b32 v96, v65, v64, 16
  v_alignbit_b32 v97, v66, v65, 16
  v_alignbit_b32 v98, v67, v66, 16
  v_alignbit_b32 v99, v68, v67, 16
  ds_write_b128 v4, v[96:99] offset:24960
  v_mov_b32 v100, v64
  v_mov_b32 v101, v65
  v_mov_b32 v102, v66
  v_mov_b32 v103, v67
  ds_write_b128 v4, v[100:103] offset:29120
  s_cmp_lg_u32 s71, 0
  s_cbranch_scc1 Lkcskip_36
  v_cmp_gt_u32 vcc, 3, v0
  s_and_saveexec_b64 s[76:77], vcc
  v_add_u32 v2, 256, v0
  v_lshlrev_b32 v5, 4, v2
  v_add_u32 v4, 0, v5
  v_add_u32 v5, 52864, v5
  ds_read_b128 v[64:67], v5
  ds_read_b128 v[68:71], v5 offset:16
  s_waitcnt lgkmcnt(0)
  v_alignbit_b32 v72, v68, v67, 16
  v_alignbit_b32 v73, v69, v68, 16
  v_alignbit_b32 v74, v70, v69, 16
  v_alignbit_b32 v75, v71, v70, 16
  ds_write_b128 v4, v[72:75] offset:0
  v_mov_b32 v76, v67
  v_mov_b32 v77, v68
  v_mov_b32 v78, v69
  v_mov_b32 v79, v70
  ds_write_b128 v4, v[76:79] offset:4160
  v_alignbit_b32 v80, v67, v66, 16
  v_alignbit_b32 v81, v68, v67, 16
  v_alignbit_b32 v82, v69, v68, 16
  v_alignbit_b32 v83, v70, v69, 16
  ds_write_b128 v4, v[80:83] offset:8320
  v_mov_b32 v84, v66
  v_mov_b32 v85, v67
  v_mov_b32 v86, v68
  v_mov_b32 v87, v69
  ds_write_b128 v4, v[84:87] offset:12480
  v_alignbit_b32 v88, v66, v65, 16
  v_alignbit_b32 v89, v67, v66, 16
  v_alignbit_b32 v90, v68, v67, 16
  v_alignbit_b32 v91, v69, v68, 16
  ds_write_b128 v4, v[88:91] offset:16640
  v_mov_b32 v92, v65
  v_mov_b32 v93, v66
  v_mov_b32 v94, v67
  v_mov_b32 v95, v68
  ds_write_b128 v4, v[92:95] offset:20800
  v_alignbit_b32 v96, v65, v64, 16
  v_alignbit_b32 v97, v66, v65, 16
  v_alignbit_b32 v98, v67, v66, 16
  v_alignbit_b32 v99, v68, v67, 16
  ds_write_b128 v4, v[96:99] offset:24960
  v_mov_b32 v100, v64
  v_mov_b32 v101, v65
  v_mov_b32 v102, v66
  v_mov_b32 v103, v67
  ds_write_b128 v4, v[100:103] offset:29120
  s_mov_b64 exec, s[76:77]
Lkcskip_36:
  s_waitcnt lgkmcnt(0)
  s_barrier
  v_and_b32 v1, 31, v0
  v_lshrrev_b32 v2, 5, v0
  v_and_b32 v3, 7, v1
  v_lshrrev_b32 v4, 3, v1
  v_mul_u32_u24 v3, 4160, v3
  v_sub_u32 v4, v2, v4
  v_add_u32 v4, 255, v4
  v_lshl_add_u32 v3, v4, 4, v3
  s_lshl_b32 s73, s71, 9
  s_add_u32 s73, s73, 2496
  s_sub_u32 s74, 0, s73
  v_add_u32 v5, s74, v3
  v_mul_u32_u24 v6, 80, v1
  v_lshl_add_u32 v6, v2, 4, v6
  s_lshl_b32 s73, s71, 3
  s_sub_u32 s73, 25, s73
  s_mul_i32 s73, s73, 80
  s_add_u32 s73, s73, 40960
  v_add_u32 v6, s73, v6
  v_mov_b32 v192, 0
  v_mov_b32 v193, 0
  v_mov_b32 v194, 0
  v_mov_b32 v195, 0
  v_mov_b32 v196, 0
  v_mov_b32 v197, 0
  v_mov_b32 v198, 0
  v_mov_b32 v199, 0
  v_mov_b32 v200, 0
  v_mov_b32 v201, 0
  v_mov_b32 v202, 0
  v_mov_b32 v203, 0
  v_mov_b32 v204, 0
  v_mov_b32 v205, 0
  v_mov_b32 v206, 0
  v_mov_b32 v207, 0
  v_mov_b32 v208, 0
  v_mov_b32 v209, 0
  v_mov_b32 v210, 0
  v_mov_b32 v211, 0
  v_mov_b32 v212, 0
  v_mov_b32 v213, 0
  v_mov_b32 v214, 0
  v_mov_b32 v215, 0
  v_mov_b32 v216, 0
  v_mov_b32 v217, 0
  v_mov_b32 v218, 0
  v_mov_b32 v219, 0
  v_mov_b32 v220, 0
  v_mov_b32 v221, 0
  v_mov_b32 v222, 0
  v_mov_b32 v223, 0
  ds_read_b128 v[8:11], v5 offset:2496
  ds_read_b128 v[12:15], v5 offset:448
  ds_read_b128 v[16:19], v6 offset:560
  ds_read_b128 v[20:23], v6 offset:3120
  ds_read_b128 v[24:27], v5 offset:2528
  ds_read_b128 v[28:31], v5 offset:480
  ds_read_b128 v[32:35], v6 offset:592
  ds_read_b128 v[36:39], v6 offset:3152
  ds_read_b128 v[40:43], v5 offset:2432
  ds_read_b128 v[44:47], v5 offset:384
  ds_read_b128 v[48:51], v6 offset:480
  ds_read_b128 v[52:55], v6 offset:3040
  ds_read_b128 v[56:59], v5 offset:2464
  ds_read_b128 v[60:63], v5 offset:416
  ds_read_b128 v[64:67], v6 offset:512
  ds_read_b128 v[68:71], v6 offset:3072
  s_waitcnt lgkmcnt(8)
  v_mfma_f32_32x32x16_f16 v[192:207], v[8:11], v[16:19], v[192:207]
  v_mfma_f32_32x32x16_f16 v[208:223], v[8:11], v[20:23], v[208:223]
  v_mfma_f32_32x32x16_f16 v[208:223], v[12:15], v[16:19], v[208:223]
  v_mfma_f32_32x32x16_f16 v[192:207], v[24:27], v[32:35], v[192:207]
  v_mfma_f32_32x32x16_f16 v[208:223], v[24:27], v[36:39], v[208:223]
  v_mfma_f32_32x32x16_f16 v[208:223], v[28:31], v[32:35], v[208:223]
  ds_read_b128 v[8:11], v5 offset:2368
  ds_read_b128 v[12:15], v5 offset:320
  ds_read_b128 v[16:19], v6 offset:400
  ds_read_b128 v[20:23], v6 offset:2960
  ds_read_b128 v[24:27], v5 offset:2400
  ds_read_b128 v[28:31], v5 offset:352
  ds_read_b128 v[32:35], v6 offset:432
  ds_read_b128 v[36:39], v6 offset:2992
  s_waitcnt lgkmcnt(8)
  v_mfma_f32_32x32x16_f16 v[192:207], v[40:43], v[48:51], v[192:207]
  v_mfma_f32_32x32x16_f16 v[208:223], v[40:43], v[52:55], v[208:223]
  v_mfma_f32_32x32x16_f16 v[208:223], v[44:47], v[48:51], v[208:223]
  v_mfma_f32_32x32x16_f16 v[192:207], v[56:59], v[64:67], v[192:207]
  v_mfma_f32_32x32x16_f16 v[208:223], v[56:59], v[68:71], v[208:223]
  v_mfma_f32_32x32x16_f16 v[208:223], v[60:63], v[64:67], v[208:223]
  ds_read_b128 v[40:43], v5 offset:2304
  ds_read_b128 v[44:47], v5 offset:256
  ds_read_b128 v[48:51], v6 offset:320
  ds_read_b128 v[52:55], v6 offset:2880
  ds_read_b128 v[56:59], v5 offset:2336
  ds_read_b128 v[60:63], v5 offset:288
  ds_read_b128 v[64:67], v6 offset:352
  ds_read_b128 v[68:71], v6 offset:2912
  s_waitcnt lgkmcnt(8)
  v_mfma_f32_32x32x16_f16 v[192:207], v[8:11], v[16:19], v[192:207]
  v_mfma_f32_32x32x16_f16 v[208:223], v[8:11], v[20:23], v[208:223]
  v_mfma_f32_32x32x16_f16 v[208:223], v[12:15], v[16:19], v[208:223]
  v_mfma_f32_32x32x16_f16 v[192:207], v[24:27], v[32:35], v[192:207]
  v_mfma_f32_32x32x16_f16 v[208:223], v[24:27], v[36:39], v[208:223]
  v_mfma_f32_32x32x16_f16 v[208:223], v[28:31], v[32:35], v[208:223]
  ds_read_b128 v[8:11], v5 offset:2240
  ds_read_b128 v[12:15], v5 offset:192
  ds_read_b128 v[16:19], v6 offset:240
  ds_read_b128 v[20:23], v6 offset:2800
  ds_read_b128 v[24:27], v5 offset:2272
  ds_read_b128 v[28:31], v5 offset:224
  ds_read_b128 v[32:35], v6 offset:272
  ds_read_b128 v[36:39], v6 offset:2832
  s_waitcnt lgkmcnt(8)
  v_mfma_f32_32x32x16_f16 v[192:207], v[40:43], v[48:51], v[192:207]
  v_mfma_f32_32x32x16_f16 v[208:223], v[40:43], v[52:55], v[208:223]
  v_mfma_f32_32x32x16_f16 v[208:223], v[44:47], v[48:51], v[208:223]
  v_mfma_f32_32x32x16_f16 v[192:207], v[56:59], v[64:67], v[192:207]
  v_mfma_f32_32x32x16_f16 v[208:223], v[56:59], v[68:71], v[208:223]
  v_mfma_f32_32x32x16_f16 v[208:223], v[60:63], v[64:67], v[208:223]
  ds_read_b128 v[40:43], v5 offset:2176
  ds_read_b128 v[44:47], v5 offset:128
  ds_read_b128 v[48:51], v6 offset:160
  ds_read_b128 v[52:55], v6 offset:2720
  ds_read_b128 v[56:59], v5 offset:2208
  ds_read_b128 v[60:63], v5 offset:160
  ds_read_b128 v[64:67], v6 offset:192
  ds_read_b128 v[68:71], v6 offset:2752
  s_waitcnt lgkmcnt(8)
  v_mfma_f32_32x32x16_f16 v[192:207], v[8:11], v[16:19], v[192:207]
  v_mfma_f32_32x32x16_f16 v[208:223], v[8:11], v[20:23], v[208:223]
  v_mfma_f32_32x32x16_f16 v[208:223], v[12:15], v[16:19], v[208:223]
  v_mfma_f32_32x32x16_f16 v[192:207], v[24:27], v[32:35], v[192:207]
  v_mfma_f32_32x32x16_f16 v[208:223], v[24:27], v[36:39], v[208:223]
  v_mfma_f32_32x32x16_f16 v[208:223], v[28:31], v[32:35], v[208:223]
  ds_read_b128 v[8:11], v5 offset:2112
  ds_read_b128 v[12:15], v5 offset:64
  ds_read_b128 v[16:19], v6 offset:80
  ds_read_b128 v[20:23], v6 offset:2640
  ds_read_b128 v[24:27], v5 offset:2144
  ds_read_b128 v[28:31], v5 offset:96
  ds_read_b128 v[32:35], v6 offset:112
  ds_read_b128 v[36:39], v6 offset:2672
  s_waitcnt lgkmcnt(8)
  v_mfma_f32_32x32x16_f16 v[192:207], v[40:43], v[48:51], v[192:207]
  v_mfma_f32_32x32x16_f16 v[208:223], v[40:43], v[52:55], v[208:223]
  v_mfma_f32_32x32x16_f16 v[208:223], v[44:47], v[48:51], v[208:223]
  v_mfma_f32_32x32x16_f16 v[192:207], v[56:59], v[64:67], v[192:207]
  v_mfma_f32_32x32x16_f16 v[208:223], v[56:59], v[68:71], v[208:223]
  v_mfma_f32_32x32x16_f16 v[208:223], v[60:63], v[64:67], v[208:223]
  ds_read_b128 v[40:43], v5 offset:2048
  ds_read_b128 v[44:47], v5 offset:0
  ds_read_b128 v[48:51], v6 offset:0
  ds_read_b128 v[52:55], v6 offset:2560
  ds_read_b128 v[56:59], v5 offset:2080
  ds_read_b128 v[60:63], v5 offset:32
  ds_read_b128 v[64:67], v6 offset:32
  ds_read_b128 v[68:71], v6 offset:2592
  s_waitcnt lgkmcnt(8)
  v_mfma_f32_32x32x16_f16 v[192:207], v[8:11], v[16:19], v[192:207]
  v_mfma_f32_32x32x16_f16 v[208:223], v[8:11], v[20:23], v[208:223]
  v_mfma_f32_32x32x16_f16 v[208:223], v[12:15], v[16:19], v[208:223]
  v_mfma_f32_32x32x16_f16 v[192:207], v[24:27], v[32:35], v[192:207]
  v_mfma_f32_32x32x16_f16 v[208:223], v[24:27], v[36:39], v[208:223]
  v_mfma_f32_32x32x16_f16 v[208:223], v[28:31], v[32:35], v[208:223]
  s_waitcnt lgkmcnt(0)
  v_mfma_f32_32x32x16_f16 v[192:207], v[40:43], v[48:51], v[192:207]
  v_mfma_f32_32x32x16_f16 v[208:223], v[40:43], v[52:55], v[208:223]
  v_mfma_f32_32x32x16_f16 v[208:223], v[44:47], v[48:51], v[208:223]
  v_mfma_f32_32x32x16_f16 v[192:207], v[56:59], v[64:67], v[192:207]
  v_mfma_f32_32x32x16_f16 v[208:223], v[56:59], v[68:71], v[208:223]
  v_mfma_f32_32x32x16_f16 v[208:223], v[60:63], v[64:67], v[208:223]
  v_lshlrev_b32 v1, 4, v0
  s_nop 7
  s_cmp_eq_u32 s71, 0
  s_cbranch_scc1 Lrs_37
  s_sub_u32 s73, s71, 1
  s_and_b32 s73, s73, 3
  s_lshl_b32 s73, s73, 11
  s_add_u32 s73, s73, 57088
  v_add_u32 v2, s73, v1
  ds_write_b128 v2, v[192:195]
  ds_write_b128 v2, v[196:199] offset:1024
Lrs_37:
  s_cmp_eq_u32 s71, 1
  s_cbranch_scc1 Lrs_38
  s_sub_u32 s73, s71, 2
  s_and_b32 s73, s73, 3
  s_lshl_b32 s73, s73, 11
  s_add_u32 s73, s73, 63232
  v_add_u32 v2, s73, v1
  ds_write_b128 v2, v[200:203]
  ds_write_b128 v2, v[204:207] offset:1024
Lrs_38:
  s_cmp_eq_u32 s71, 2
  s_cbranch_scc1 Lrs_39
  s_sub_u32 s73, s71, 3
  s_and_b32 s73, s73, 3
  s_lshl_b32 s73, s73, 11
  s_add_u32 s73, s73, 69376
  v_add_u32 v2, s73, v1
  ds_write_b128 v2, v[208:211]
  ds_write_b128 v2, v[212:215] offset:1024
Lrs_39:
  s_cmp_eq_u32 s71, 3
  s_cbranch_scc1 Lrs_40
  s_sub_u32 s73, s71, 4
  s_and_b32 s73, s73, 3
  s_lshl_b32 s73, s73, 11
  s_add_u32 s73, s73, 75520
  v_add_u32 v2, s73, v1
  ds_write_b128 v2, v[216:219]
  ds_write_b128 v2, v[220:223] offset:1024
Lrs_40:
  s_cmp_lg_u32 s71, 0
  s_cbranch_scc1 Lmv_42
  v_mov_b32 v8, v192
  v_mov_b32 v9, v193
  v_mov_b32 v10, v194
  v_mov_b32 v11, v195
  v_mov_b32 v12, v196
  v_mov_b32 v13, v197
  v_mov_b32 v14, v198
  v_mov_b32 v15, v199
  s_branch Lmvd_41
Lmv_42:
  s_cmp_lg_u32 s71, 1
  s_cbranch_scc1 Lmv_43
  v_mov_b32 v8, v200
  v_mov_b32 v9, v201
  v_mov_b32 v10, v202
  v_mov_b32 v11, v203
  v_mov_b32 v12, v204
  v_mov_b32 v13, v205
  v_mov_b32 v14, v206
  v_mov_b32 v15, v207
  s_branch Lmvd_41
Lmv_43:
  s_cmp_lg_u32 s71, 2
  s_cbranch_scc1 Lmv_44
  v_mov_b32 v8, v208
  v_mov_b32 v9, v209
  v_mov_b32 v10, v210
  v_mov_b32 v11, v211
  v_mov_b32 v12, v212
  v_mov_b32 v13, v213
  v_mov_b32 v14, v214
  v_mov_b32 v15, v215
  s_branch Lmvd_41
Lmv_44:
  s_cmp_lg_u32 s71, 3
  s_cbranch_scc1 Lmv_45
  v_mov_b32 v8, v216
  v_mov_b32 v9, v217
  v_mov_b32 v10, v218
  v_mov_b32 v11, v219
  v_mov_b32 v12, v220
  v_mov_b32 v13, v221
  v_mov_b32 v14, v222
  v_mov_b32 v15, v223
  s_branch Lmvd_41
Lmv_45:
Lmvd_41:
  s_waitcnt lgkmcnt(0)
  s_barrier
  s_mul_i32 s73, s71, 6144
  s_add_u32 s73, s73, 57088
  v_add_u32 v2, s73, v1
  ds_read_b128 v[16:19], v2 offset:0
  ds_read_b128 v[20:23], v2 offset:1024
  ds_read_b128 v[24:27], v2 offset:2048
  ds_read_b128 v[28:31], v2 offset:3072
  ds_read_b128 v[32:35], v2 offset:4096
  ds_read_b128 v[36:39], v2 offset:5120
  v_and_b32 v3, 31, v0
  v_lshrrev_b32 v4, 5, v0
  s_lshr_b32 s73, s71, 1
  s_lshl_b32 s73, s73, 5
  s_and_b32 s74, s71, 1
  s_lshl_b32 s74, s74, 4
  v_add_u32 v5, s73, v3
  v_mul_u32_u24 v6, 80, v5
  v_lshl_add_u32 v6, v4, 3, v6
  s_lshl_b32 s76, s74, 1
  s_add_u32 s75, s76, 43520
  v_add_u32 v6, s75, v6
  ds_read_b64 v[40:41], v6
  ds_read_b64 v[42:43], v6 offset:16
  v_lshlrev_b32 v5, 5, v5
  v_lshl_add_u32 v5, v4, 2, v5
  v_add_u32 v5, s74, v5
  v_lshlrev_b32 v5, 1, v5
  s_add_u32 s75, s72, 1
  s_lshl_b32 s75, s75, 12
  s_add_u32 s74, s46, s75
  s_addc_u32 s75, s47, 0
  s_add_u32 s74, s74, 9437184
  s_addc_u32 s75, s75, 0
  s_waitcnt lgkmcnt(0)
  v_add_f32 v8, v8, v16
  v_add_f32 v24, v24, v32
  v_add_f32 v8, v8, v24
  v_mul_f32 v8, v241, v8
  v_add_f32 v9, v9, v17
  v_add_f32 v25, v25, v33
  v_add_f32 v9, v9, v25
  v_mul_f32 v9, v241, v9
  v_add_f32 v10, v10, v18
  v_add_f32 v26, v26, v34
  v_add_f32 v10, v10, v26
  v_mul_f32 v10, v241, v10
  v_add_f32 v11, v11, v19
  v_add_f32 v27, v27, v35
  v_add_f32 v11, v11, v27
  v_mul_f32 v11, v241, v11
  v_add_f32 v12, v12, v20
  v_add_f32 v28, v28, v36
  v_add_f32 v12, v12, v28
  v_mul_f32 v12, v241, v12
  v_add_f32 v13, v13, v21
  v_add_f32 v29, v29, v37
  v_add_f32 v13, v13, v29
  v_mul_f32 v13, v241, v13
  v_add_f32 v14, v14, v22
  v_add_f32 v30, v30, v38
  v_add_f32 v14, v14, v30
  v_mul_f32 v14, v241, v14
  v_add_f32 v15, v15, v23
  v_add_f32 v31, v31, v39
  v_add_f32 v15, v15, v31
  v_mul_f32 v15, v241, v15
  v_cvt_f32_f16 v44, v40
  v_cvt_f32_f16 v46, v41
  v_cvt_f32_f16 v48, v42
  v_cvt_f32_f16 v50, v43
  v_cvt_f32_f16_sdwa v45, v40 dst_sel:DWORD dst_unused:UNUSED_PAD src0_sel:WORD_1
  v_cvt_f32_f16_sdwa v47, v41 dst_sel:DWORD dst_unused:UNUSED_PAD src0_sel:WORD_1
  v_cvt_f32_f16_sdwa v49, v42 dst_sel:DWORD dst_unused:UNUSED_PAD src0_sel:WORD_1
  v_cvt_f32_f16_sdwa v51, v43 dst_sel:DWORD dst_unused:UNUSED_PAD src0_sel:WORD_1
  v_mul_f32 v44, v239, v44
  v_mul_f32 v46, v239, v46
  v_mul_f32 v48, v239, v48
  v_mul_f32 v50, v239, v50
  v_mul_f32 v45, v239, v45
  v_mul_f32 v47, v239, v47
  v_mul_f32 v49, v239, v49
  v_mul_f32 v51, v239, v51
  v_cvt_pk_bf16_f32 v52, v44, v45
  v_cvt_pk_bf16_f32 v53, v46, v47
  v_cvt_pk_bf16_f32 v54, v48, v49
  v_cvt_pk_bf16_f32 v55, v50, v51
  v_cvt_pk_bf16_f32 v56, v8, v9
  v_cvt_pk_bf16_f32 v57, v10, v11
  v_cvt_pk_bf16_f32 v58, v12, v13
  v_cvt_pk_bf16_f32 v59, v14, v15
  v_lshlrev_b32 v44, 16, v52
  v_lshlrev_b32 v46, 16, v53
  v_lshlrev_b32 v48, 16, v54
  v_lshlrev_b32 v50, 16, v55
  v_and_b32 v45, 0xffff0000, v52
  v_and_b32 v47, 0xffff0000, v53
  v_and_b32 v49, 0xffff0000, v54
  v_and_b32 v51, 0xffff0000, v55
  v_lshlrev_b32 v8, 16, v56
  v_lshlrev_b32 v10, 16, v57
  v_lshlrev_b32 v12, 16, v58
  v_lshlrev_b32 v14, 16, v59
  v_and_b32 v9, 0xffff0000, v56
  v_and_b32 v11, 0xffff0000, v57
  v_and_b32 v13, 0xffff0000, v58
  v_and_b32 v15, 0xffff0000, v59
  v_add_f32 v8, v8, v44
  v_add_f32 v10, v10, v46
  v_add_f32 v12, v12, v48
  v_add_f32 v14, v14, v50
  v_add_f32 v9, v9, v45
  v_add_f32 v11, v11, v47
  v_add_f32 v13, v13, v49
  v_add_f32 v15, v15, v51
  v_cvt_pk_bf16_f32 v60, v8, v9
  v_cvt_pk_bf16_f32 v61, v10, v11
  v_cvt_pk_bf16_f32 v62, v12, v13
  v_cvt_pk_bf16_f32 v63, v14, v15
  global_store_dwordx2 v5, v[60:61], s[74:75] sc1
  global_store_dwordx2 v5, v[62:63], s[74:75] offset:16 sc1
  s_waitcnt vmcnt(0)
  s_barrier
  s_cmp_lg_u32 s50, 0
  s_cbranch_scc1 Lfs_46
  s_lshl_b32 s6, s4, 5
  s_add_u32 s6, s6, s5
  s_lshl_b32 s6, s6, 3
  s_add_u32 s6, s6, 12587008
  v_mov_b32 v244, s6
  v_mov_b32 v246, s8
  v_mov_b32 v247, s9
  s_mov_b64 s[6:7], exec
  s_mov_b64 exec, 1
  global_store_dwordx2 v244, v[246:247], s[46:47] sc1
  s_mov_b64 exec, s[6:7]
Lfs_46:
  s_waitcnt vmcnt(0)
Lend:
  s_endpgm
.section .rodata,"a"
.p2align 6
.amdhsa_kernel recurrent_scan__ssm_conv_s4__glu_gated_glu__prompt_kernel
  .amdhsa_next_free_vgpr 256
  .amdhsa_next_free_sgpr 102
  .amdhsa_accum_offset 256
  .amdhsa_group_segment_fixed_size 0
  .amdhsa_kernarg_size 128
  .amdhsa_user_sgpr_count 2
  .amdhsa_user_sgpr_kernarg_segment_ptr 1
  .amdhsa_system_sgpr_workgroup_id_x 1
.end_amdhsa_kernel
```
